```python
import torch

def _softmax(x, axis=-1):
    return torch.softmax(x, dim=axis)

def _gelu(x):
    return torch.nn.functional.gelu(x, approximate='tanh')

def _silu(x):
    return torch.nn.functional.silu(x)

def _sigmoid(x):
    return torch.sigmoid(x)

def _layernorm(x, axis=-1, eps=1e-05):
    m = x.mean(dim=axis, keepdim=True)
    v = x.var(dim=axis, keepdim=True, unbiased=False)
    return (x - m) / torch.sqrt(v + eps)

def _scatter_add(tgt, idx, src, axis=0):
    return tgt.clone().index_add_(axis, idx, src)

def _segment_sum(src, seg, n):
    out = torch.zeros((n,) + src.shape[1:], dtype=src.dtype)
    return out.index_add_(0, seg, src)

def _pad(x, pw):
    flat = tuple((v for pair in reversed(pw) for v in pair))
    return torch.nn.functional.pad(x, flat)
kernel_name = 'standalone__dilated_atrous__vision'

def setup_inputs():

    _w = lambda a: (lambda t: t.to(torch.bfloat16) if t.is_floating_point() else t)(torch.as_tensor(a))
    H = W = 224
    C = 96
    k = 7
    return {'x': _w((lambda *s: torch.randn(*s, dtype=torch.bfloat16) * 0.05)(1, H, W, C)), 'w': _w((lambda *s: torch.randn(*s, dtype=torch.bfloat16) * 0.05)(k, k, C, C) * (1.0 / (k * C ** 0.5)))}

def reference(x, w):
    B, H, W, C = x.shape
    k = 7
    rate = 2
    pad = (k - 1) * rate // 2
    xp = _pad(x, ((0, 0), (pad, pad), (pad, pad), (0, 0)))
    out = torch.zeros_like(x)
    for i in range(k):
        for j in range(k):
            tap = xp[:, i * rate:i * rate + H, j * rate:j * rate + W, :].clone()
            out = out + torch.einsum('bhwc,co->bhwo', tap, w[i, j])
    return out
```

```asm
; @launch grid=(256,1,1) block=(320,1,1) lds=152576
.amdgcn_target "amdgcn-amd-amdhsa--gfx950"
.text
.globl standalone__dilated_atrous__vision_kernel
.p2align 8
.type standalone__dilated_atrous__vision_kernel,@function
standalone__dilated_atrous__vision_kernel:
    s_load_dwordx4 s[4:7], s[0:1], 0
    s_load_dwordx4 s[8:11], s[0:1], 16
    s_cmp_ge_u32 s2, 256
    s_cbranch_scc1 L_end
    v_lshrrev_b32 v4, 6, v0
    v_and_b32 v1, 63, v0
    s_and_b32 s37, s2, 7
    v_readfirstlane_b32 s24, v4
    s_lshr_b32 s55, s2, 3
    s_and_b32 s38, s37, 1
    s_lshl_b32 s39, s38, 5
    s_add_u32 s40, s39, s55
    s_cmp_eq_u32 s40, 63
    s_cbranch_scc1 L_end
    s_getpc_b64 s[92:93]
L_pc0:
    s_sub_u32 s38, s24, 2
    v_lshlrev_b32 v6, 7, v1
    s_cmp_gt_u32 s38, 1
    s_cbranch_scc1 L_nocpf
    s_lshl_b32 s38, s38, 13
    v_add_u32 v6, s38, v6
    v_min_u32 v6, L_end-L_pc0, v6
    global_load_dword v14, v6, s[92:93]
L_nocpf:
    s_lshr_b32 s37, s37, 1
    s_mul_i32 s37, s37, 63
    s_add_u32 s37, s37, s40
    s_mul_i32 s38, s37, 5462
    s_lshr_b32 s38, s38, 16
    s_mul_i32 s39, s38, 12
    s_sub_u32 s37, s37, s39
    s_mul_i32 s39, s37, 86
    s_lshr_b32 s39, s39, 8
    s_mul_i32 s40, s39, 3
    s_sub_u32 s25, s37, s40
    s_lshl_b32 s25, s25, 6
    s_lshr_b32 s40, s39, 1
    s_mul_i32 s40, s40, 43008
    s_and_b32 s39, s39, 1
    s_mul_i32 s39, s39, 192
    s_add_u32 s32, s39, s40
    s_mul_i32 s39, s38, 37
    s_lshr_b32 s39, s39, 8
    s_mul_i32 s40, s39, 7
    s_sub_u32 s33, s38, s40
    s_mul_i32 s34, s39, 38
    s_lshr_b32 s40, s39, 1
    s_sub_u32 s34, s34, s40
    s_cmp_eq_u32 s39, 0
    s_cselect_b32 s26, 38, 37
    s_sub_u32 s27, s34, 3
    s_lshr_b32 s35, s24, 1
    s_add_u32 s35, s35, 36
    s_cmp_lt_u32 s35, s26
    s_cselect_b32 s47, 1, 0
    s_mov_b32 s56, 0xffffff
    s_mov_b32 s57, 0
    s_cmp_eq_u32 s24, 4
    s_cbranch_scc1 L_loader
    v_lshrrev_b32 v4, 2, v1
    v_lshrrev_b32 v5, 1, v4
    v_and_b32 v5, 2, v5
    v_and_b32 v6, 3, v1
    v_xor_b32 v5, v5, v6
    v_lshlrev_b32 v5, 4, v5
    v_bfrev_b32 v7, 1
    s_lshl_b32 s37, s33, 4
    s_add_u32 s37, s37, 4093
    s_sub_u32 s37, s37, 4096
    v_add_u32 v6, s37, v4
    v_mul_u32_u24 v16, 384, v6
    v_cmp_gt_u32 vcc, 112, v6
    v_add_u32 v16, v16, v5
    s_nop 0
    v_cndmask_b32 v16, v7, v16, vcc
    s_lshl_b32 s37, s33, 4
    s_add_u32 s37, s37, 4109
    s_sub_u32 s37, s37, 4096
    v_add_u32 v6, s37, v4
    v_mul_u32_u24 v15, 384, v6
    v_cmp_gt_u32 vcc, 112, v6
    v_add_u32 v15, v15, v5
    s_nop 0
    v_cndmask_b32 v15, v7, v15, vcc
    s_mul_i32 s58, s24, 11
    s_add_u32 s59, s27, s58
    s_mul_i32 s91, s59, 86016
    s_add_u32 s91, s91, s32
    s_mul_i32 m0, s58, 1408
    v_and_b32 v2, 15, v1
    v_lshrrev_b32 v3, 4, v1
    s_waitcnt lgkmcnt(0)
    s_mov_b32 s12, s4
    s_and_b32 s13, s5, 0xffff
    s_mov_b32 s14, 9633792
    s_mov_b32 s15, 0x20000
    s_mov_b32 s20, s8
    s_and_b32 s21, s9, 0xffff
    s_mov_b32 s22, 9633792
    s_mov_b32 s23, 0x20000
    s_mov_b32 s38, s59
    s_mov_b32 s39, s91
    s_cmp_lt_u32 s38, 112
    s_cselect_b32 s62, s39, 0x40000000
    buffer_load_dwordx4 v16, s[12:15], s62 offen lds
    s_add_u32 m0, m0, 1408
    s_add_u32 s38, s38, 1
    s_add_u32 s39, s39, 86016
    s_cmp_lt_u32 s38, 112
    s_cselect_b32 s62, s39, 0x40000000
    buffer_load_dwordx4 v16, s[12:15], s62 offen lds
    s_add_u32 m0, m0, 1408
    s_add_u32 s38, s38, 1
    s_add_u32 s39, s39, 86016
    s_cmp_lt_u32 s38, 112
    s_cselect_b32 s62, s39, 0x40000000
    buffer_load_dwordx4 v16, s[12:15], s62 offen lds
    s_add_u32 m0, m0, 1408
    s_add_u32 s38, s38, 1
    s_add_u32 s39, s39, 86016
    s_cmp_lt_u32 s38, 112
    s_cselect_b32 s62, s39, 0x40000000
    buffer_load_dwordx4 v16, s[12:15], s62 offen lds
    s_add_u32 m0, m0, 1408
    s_add_u32 s38, s38, 1
    s_add_u32 s39, s39, 86016
    s_cmp_lt_u32 s38, 112
    s_cselect_b32 s62, s39, 0x40000000
    buffer_load_dwordx4 v16, s[12:15], s62 offen lds
    s_add_u32 m0, m0, 1408
    s_add_u32 s38, s38, 1
    s_add_u32 s39, s39, 86016
    s_cmp_lt_u32 s38, 112
    s_cselect_b32 s62, s39, 0x40000000
    buffer_load_dwordx4 v16, s[12:15], s62 offen lds
    s_add_u32 m0, m0, 1408
    s_add_u32 s38, s38, 1
    s_add_u32 s39, s39, 86016
    s_cmp_lt_u32 s38, 112
    s_cselect_b32 s62, s39, 0x40000000
    buffer_load_dwordx4 v16, s[12:15], s62 offen lds
    s_add_u32 m0, m0, 1408
    s_add_u32 s38, s38, 1
    s_add_u32 s39, s39, 86016
    s_cmp_lt_u32 s38, 112
    s_cselect_b32 s62, s39, 0x40000000
    buffer_load_dwordx4 v16, s[12:15], s62 offen lds
    s_add_u32 m0, m0, 1408
    s_add_u32 s38, s38, 1
    s_add_u32 s39, s39, 86016
    s_cmp_lt_u32 s38, 112
    s_cselect_b32 s62, s39, 0x40000000
    buffer_load_dwordx4 v16, s[12:15], s62 offen lds
    s_add_u32 m0, m0, 1408
    s_add_u32 s38, s38, 1
    s_add_u32 s39, s39, 86016
    s_cmp_lt_u32 s38, 112
    s_cselect_b32 s62, s39, 0x40000000
    buffer_load_dwordx4 v16, s[12:15], s62 offen lds
    s_add_u32 m0, m0, 1408
    s_add_u32 s38, s38, 1
    s_add_u32 s39, s39, 86016
    s_cmp_lt_u32 s38, 112
    s_cselect_b32 s62, s39, 0x40000000
    buffer_load_dwordx4 v16, s[12:15], s62 offen lds
    s_setprio 2
    v_mov_b32 v16, 0
    v_mov_b32 v17, 0
    v_mov_b32 v18, 0
    v_mov_b32 v19, 0
    v_mov_b32 v20, 0
    v_mov_b32 v21, 0
    v_mov_b32 v22, 0
    v_mov_b32 v23, 0
    v_mov_b32 v24, 0
    v_mov_b32 v25, 0
    v_mov_b32 v26, 0
    v_mov_b32 v27, 0
    v_mov_b32 v28, 0
    v_mov_b32 v29, 0
    v_mov_b32 v30, 0
    v_mov_b32 v31, 0
    v_mov_b32 v32, 0
    v_mov_b32 v33, 0
    v_mov_b32 v34, 0
    v_mov_b32 v35, 0
    v_mov_b32 v36, 0
    v_mov_b32 v37, 0
    v_mov_b32 v38, 0
    v_mov_b32 v39, 0
    v_mov_b32 v40, 0
    v_mov_b32 v41, 0
    v_mov_b32 v42, 0
    v_mov_b32 v43, 0
    v_mov_b32 v44, 0
    v_mov_b32 v45, 0
    v_mov_b32 v46, 0
    v_mov_b32 v47, 0
    v_mov_b32 v48, 0
    v_mov_b32 v49, 0
    v_mov_b32 v50, 0
    v_mov_b32 v51, 0
    v_mov_b32 v52, 0
    v_mov_b32 v53, 0
    v_mov_b32 v54, 0
    v_mov_b32 v55, 0
    v_mov_b32 v56, 0
    v_mov_b32 v57, 0
    v_mov_b32 v58, 0
    v_mov_b32 v59, 0
    v_mov_b32 v60, 0
    v_mov_b32 v61, 0
    v_mov_b32 v62, 0
    v_mov_b32 v63, 0
    v_mov_b32 v64, 0
    v_mov_b32 v65, 0
    v_mov_b32 v66, 0
    v_mov_b32 v67, 0
    v_mov_b32 v68, 0
    v_mov_b32 v69, 0
    v_mov_b32 v70, 0
    v_mov_b32 v71, 0
    v_mov_b32 v72, 0
    v_mov_b32 v73, 0
    v_mov_b32 v74, 0
    v_mov_b32 v75, 0
    v_mov_b32 v76, 0
    v_mov_b32 v77, 0
    v_mov_b32 v78, 0
    v_mov_b32 v79, 0
    v_mov_b32 v80, 0
    v_mov_b32 v81, 0
    v_mov_b32 v82, 0
    v_mov_b32 v83, 0
    v_mov_b32 v84, 0
    v_mov_b32 v85, 0
    v_mov_b32 v86, 0
    v_mov_b32 v87, 0
    v_mov_b32 v88, 0
    v_mov_b32 v89, 0
    v_mov_b32 v90, 0
    v_mov_b32 v91, 0
    v_lshrrev_b32 v4, 1, v3
    v_lshlrev_b32 v4, 4, v4
    v_and_b32 v5, 1, v3
    v_lshl_add_u32 v4, v5, 2, v4
    v_lshrrev_b32 v6, 2, v2
    v_add_u32 v4, v4, v6
    v_lshlrev_b32 v4, 6, v4
    v_and_b32 v6, 3, v2
    v_lshl_add_u32 v4, v6, 3, v4
    v_add_u32 v4, 123904, v4
    v_lshlrev_b32 v5, 5, v5
    s_add_u32 s93, s24, 0
    s_and_b32 s93, s93, 1
    s_lshl_b32 s93, s93, 5
    v_xor_b32 v6, s93, v5
    v_add_u32 v8, v6, v4
    s_add_u32 s94, s24, 1
    s_and_b32 s94, s94, 1
    s_lshl_b32 s94, s94, 5
    v_xor_b32 v6, s94, v5
    v_add_u32 v9, v6, v4
    s_mov_b32 s51, 14336
    s_mov_b32 s48, 0
    s_mov_b32 s49, 0
    s_mov_b32 s50, 0
    s_mul_i32 s41, s35, 1408
    s_mul_i32 s52, s24, 9
    s_sub_u32 s52, s52, s35
    s_mul_i32 s52, s52, 1408
    s_and_b32 s37, s50, 1
    s_mul_i32 s37, s37, 61952
    s_add_u32 s37, s37, s41
    v_add_u32 v4, s49, v2
    v_lshrrev_b32 v5, 1, v4
    v_and_b32 v5, 2, v5
    v_xor_b32 v5, v5, v3
    v_lshlrev_b32 v5, 4, v5
    v_lshl_add_u32 v5, v4, 6, v5
    v_add_u32 v12, s37, v5
    v_add_u32 v11, s52, v12
    s_mul_i32 s37, s58, 1408
    s_add_u32 m0, s37, 1024
    s_mov_b64 exec, 0xff
    s_cmp_lt_u32 s59, 112
    s_cselect_b32 s62, s91, 0x40000000
    buffer_load_dwordx4 v15, s[12:15], s62 offen lds
    s_add_u32 m0, m0, 1408
    s_add_u32 s59, s59, 1
    s_add_u32 s91, s91, 86016
    s_cmp_lt_u32 s59, 112
    s_cselect_b32 s62, s91, 0x40000000
    buffer_load_dwordx4 v15, s[12:15], s62 offen lds
    s_add_u32 m0, m0, 1408
    s_add_u32 s59, s59, 1
    s_add_u32 s91, s91, 86016
    s_cmp_lt_u32 s59, 112
    s_cselect_b32 s62, s91, 0x40000000
    buffer_load_dwordx4 v15, s[12:15], s62 offen lds
    s_add_u32 m0, m0, 1408
    s_add_u32 s59, s59, 1
    s_add_u32 s91, s91, 86016
    s_cmp_lt_u32 s59, 112
    s_cselect_b32 s62, s91, 0x40000000
    buffer_load_dwordx4 v15, s[12:15], s62 offen lds
    s_add_u32 m0, m0, 1408
    s_add_u32 s59, s59, 1
    s_add_u32 s91, s91, 86016
    s_cmp_lt_u32 s59, 112
    s_cselect_b32 s62, s91, 0x40000000
    buffer_load_dwordx4 v15, s[12:15], s62 offen lds
    s_add_u32 m0, m0, 1408
    s_add_u32 s59, s59, 1
    s_add_u32 s91, s91, 86016
    s_cmp_lt_u32 s59, 112
    s_cselect_b32 s62, s91, 0x40000000
    buffer_load_dwordx4 v15, s[12:15], s62 offen lds
    s_add_u32 m0, m0, 1408
    s_add_u32 s59, s59, 1
    s_add_u32 s91, s91, 86016
    s_cmp_lt_u32 s59, 112
    s_cselect_b32 s62, s91, 0x40000000
    buffer_load_dwordx4 v15, s[12:15], s62 offen lds
    s_add_u32 m0, m0, 1408
    s_add_u32 s59, s59, 1
    s_add_u32 s91, s91, 86016
    s_cmp_lt_u32 s59, 112
    s_cselect_b32 s62, s91, 0x40000000
    buffer_load_dwordx4 v15, s[12:15], s62 offen lds
    s_add_u32 m0, m0, 1408
    s_add_u32 s59, s59, 1
    s_add_u32 s91, s91, 86016
    s_cmp_lt_u32 s59, 112
    s_cselect_b32 s62, s91, 0x40000000
    buffer_load_dwordx4 v15, s[12:15], s62 offen lds
    s_add_u32 m0, m0, 1408
    s_add_u32 s59, s59, 1
    s_add_u32 s91, s91, 86016
    s_cmp_lt_u32 s59, 112
    s_cselect_b32 s62, s91, 0x40000000
    buffer_load_dwordx4 v15, s[12:15], s62 offen lds
    s_add_u32 m0, m0, 1408
    s_add_u32 s59, s59, 1
    s_add_u32 s91, s91, 86016
    s_cmp_lt_u32 s59, 112
    s_cselect_b32 s62, s91, 0x40000000
    buffer_load_dwordx4 v15, s[12:15], s62 offen lds
    s_mov_b64 exec, -1
    s_cmp_eq_u32 s24, 3
    s_cbranch_scc1 L_wA3
    s_waitcnt vmcnt(11)
L_wA3:
    s_waitcnt vmcnt(18)
    s_barrier
    ds_read_b64_tr_b16 a[0:1], v8 offset:0
    ds_read_b64_tr_b16 a[2:3], v8 offset:512
    ds_read_b128 a[56:59], v11 offset:0
    ds_read_b128 a[60:63], v11 offset:1408
    ds_read_b128 a[64:67], v11 offset:2816
    ds_read_b128 a[68:71], v11 offset:4224
    ds_read_b128 a[72:75], v11 offset:5632
    ds_read_b128 a[76:79], v11 offset:7040
    ds_read_b128 a[80:83], v11 offset:8448
    ds_read_b128 a[84:87], v11 offset:9856
    ds_read_b128 a[88:91], v11 offset:11264
    ds_read_b64_tr_b16 a[4:5], v8 offset:2048
    ds_read_b64_tr_b16 a[6:7], v8 offset:2560
    ds_read_b128 a[92:95], v11 offset:12672
    s_waitcnt lgkmcnt(11)
    v_mfma_f32_16x16x32_bf16 v[16:19], a[0:3], a[56:59], v[16:19]
    s_waitcnt lgkmcnt(10)
    v_mfma_f32_16x16x32_bf16 v[24:27], a[0:3], a[60:63], v[24:27]
    s_waitcnt lgkmcnt(9)
    v_mfma_f32_16x16x32_bf16 v[32:35], a[0:3], a[64:67], v[32:35]
    ds_read_b64_tr_b16 a[28:29], v9 offset:0
    s_waitcnt lgkmcnt(9)
    v_mfma_f32_16x16x32_bf16 v[40:43], a[0:3], a[68:71], v[40:43]
    ds_read_b64_tr_b16 a[30:31], v9 offset:512
    s_waitcnt lgkmcnt(9)
    v_mfma_f32_16x16x32_bf16 v[48:51], a[0:3], a[72:75], v[48:51]
    ds_read_b64_tr_b16 a[32:33], v9 offset:2048
    s_waitcnt lgkmcnt(9)
    v_mfma_f32_16x16x32_bf16 v[56:59], a[0:3], a[76:79], v[56:59]
    ds_read_b64_tr_b16 a[34:35], v9 offset:2560
    s_waitcnt lgkmcnt(9)
    v_mfma_f32_16x16x32_bf16 v[64:67], a[0:3], a[80:83], v[64:67]
    s_waitcnt lgkmcnt(8)
    v_mfma_f32_16x16x32_bf16 v[72:75], a[0:3], a[84:87], v[72:75]
    s_waitcnt lgkmcnt(7)
    v_mfma_f32_16x16x32_bf16 v[80:83], a[0:3], a[88:91], v[80:83]
    s_waitcnt vmcnt(16)
    s_barrier
    ds_read_b64_tr_b16 a[8:9], v8 offset:4096
    ds_read_b64_tr_b16 a[10:11], v8 offset:4608
    ds_read_b128 a[96:99], v11 offset:14080
    s_waitcnt lgkmcnt(7)
    v_mfma_f32_16x16x32_bf16 v[16:19], a[4:7], a[60:63], v[16:19]
    ds_read_b64_tr_b16 a[12:13], v8 offset:6144
    v_mfma_f32_16x16x32_bf16 v[24:27], a[4:7], a[64:67], v[24:27]
    ds_read_b64_tr_b16 a[14:15], v8 offset:6656
    v_mfma_f32_16x16x32_bf16 v[32:35], a[4:7], a[68:71], v[32:35]
    ds_read_b128 a[100:103], v11 offset:15488
    v_mfma_f32_16x16x32_bf16 v[40:43], a[4:7], a[72:75], v[40:43]
    ds_read_b64_tr_b16 a[36:37], v9 offset:4096
    v_mfma_f32_16x16x32_bf16 v[48:51], a[4:7], a[76:79], v[48:51]
    ds_read_b64_tr_b16 a[38:39], v9 offset:4608
    v_mfma_f32_16x16x32_bf16 v[56:59], a[4:7], a[80:83], v[56:59]
    ds_read_b64_tr_b16 a[40:41], v9 offset:6144
    v_mfma_f32_16x16x32_bf16 v[64:67], a[4:7], a[84:87], v[64:67]
    ds_read_b64_tr_b16 a[42:43], v9 offset:6656
    v_mfma_f32_16x16x32_bf16 v[72:75], a[4:7], a[88:91], v[72:75]
    v_mfma_f32_16x16x32_bf16 v[80:83], a[4:7], a[92:95], v[80:83]
    s_waitcnt lgkmcnt(7)
    v_mfma_f32_16x16x32_bf16 v[16:19], a[8:11], a[64:67], v[16:19]
    v_mfma_f32_16x16x32_bf16 v[24:27], a[8:11], a[68:71], v[24:27]
    v_mfma_f32_16x16x32_bf16 v[32:35], a[8:11], a[72:75], v[32:35]
    v_mfma_f32_16x16x32_bf16 v[40:43], a[8:11], a[76:79], v[40:43]
    v_mfma_f32_16x16x32_bf16 v[48:51], a[8:11], a[80:83], v[48:51]
    v_mfma_f32_16x16x32_bf16 v[56:59], a[8:11], a[84:87], v[56:59]
    v_mfma_f32_16x16x32_bf16 v[64:67], a[8:11], a[88:91], v[64:67]
    v_mfma_f32_16x16x32_bf16 v[72:75], a[8:11], a[92:95], v[72:75]
    v_mfma_f32_16x16x32_bf16 v[80:83], a[8:11], a[96:99], v[80:83]
    s_waitcnt vmcnt(11)
    s_barrier
    ds_read_b64_tr_b16 a[16:17], v8 offset:8192
    ds_read_b64_tr_b16 a[18:19], v8 offset:8704
    ds_read_b128 a[104:107], v11 offset:16896
    s_waitcnt lgkmcnt(3)
    v_mfma_f32_16x16x32_bf16 v[16:19], a[12:15], a[68:71], v[16:19]
    ds_read_b64_tr_b16 a[20:21], v8 offset:10240
    v_mfma_f32_16x16x32_bf16 v[24:27], a[12:15], a[72:75], v[24:27]
    ds_read_b64_tr_b16 a[22:23], v8 offset:10752
    v_mfma_f32_16x16x32_bf16 v[32:35], a[12:15], a[76:79], v[32:35]
    ds_read_b128 a[108:111], v11 offset:18304
    v_mfma_f32_16x16x32_bf16 v[40:43], a[12:15], a[80:83], v[40:43]
    ds_read_b64_tr_b16 a[24:25], v8 offset:12288
    v_mfma_f32_16x16x32_bf16 v[48:51], a[12:15], a[84:87], v[48:51]
    ds_read_b64_tr_b16 a[26:27], v8 offset:12800
    v_mfma_f32_16x16x32_bf16 v[56:59], a[12:15], a[88:91], v[56:59]
    ds_read_b128 a[112:115], v11 offset:19712
    v_mfma_f32_16x16x32_bf16 v[64:67], a[12:15], a[92:95], v[64:67]
    ds_read_b64_tr_b16 a[44:45], v9 offset:8192
    v_mfma_f32_16x16x32_bf16 v[72:75], a[12:15], a[96:99], v[72:75]
    ds_read_b64_tr_b16 a[46:47], v9 offset:8704
    v_mfma_f32_16x16x32_bf16 v[80:83], a[12:15], a[100:103], v[80:83]
    ds_read_b64_tr_b16 a[48:49], v9 offset:10240
    s_waitcnt lgkmcnt(9)
    v_mfma_f32_16x16x32_bf16 v[16:19], a[16:19], a[72:75], v[16:19]
    ds_read_b64_tr_b16 a[50:51], v9 offset:10752
    v_mfma_f32_16x16x32_bf16 v[24:27], a[16:19], a[76:79], v[24:27]
    ds_read_b64_tr_b16 a[52:53], v9 offset:12288
    v_mfma_f32_16x16x32_bf16 v[32:35], a[16:19], a[80:83], v[32:35]
    ds_read_b64_tr_b16 a[54:55], v9 offset:12800
    v_mfma_f32_16x16x32_bf16 v[40:43], a[16:19], a[84:87], v[40:43]
    ds_read_b128 a[116:119], v12 offset:0
    v_mfma_f32_16x16x32_bf16 v[48:51], a[16:19], a[88:91], v[48:51]
    ds_read_b128 a[120:123], v12 offset:1408
    v_mfma_f32_16x16x32_bf16 v[56:59], a[16:19], a[92:95], v[56:59]
    ds_read_b128 a[124:127], v12 offset:2816
    v_mfma_f32_16x16x32_bf16 v[64:67], a[16:19], a[96:99], v[64:67]
    ds_read_b128 a[128:131], v12 offset:4224
    v_mfma_f32_16x16x32_bf16 v[72:75], a[16:19], a[100:103], v[72:75]
    ds_read_b128 a[132:135], v12 offset:5632
    v_mfma_f32_16x16x32_bf16 v[80:83], a[16:19], a[104:107], v[80:83]
    ds_read_b128 a[136:139], v12 offset:7040
    s_waitcnt lgkmcnt(9)
    v_mfma_f32_16x16x32_bf16 v[16:19], a[20:23], a[76:79], v[16:19]
    ds_read_b128 a[140:143], v12 offset:8448
    v_mfma_f32_16x16x32_bf16 v[24:27], a[20:23], a[80:83], v[24:27]
    v_mfma_f32_16x16x32_bf16 v[32:35], a[20:23], a[84:87], v[32:35]
    v_add_u32 v8, s51, v8
    v_mfma_f32_16x16x32_bf16 v[40:43], a[20:23], a[88:91], v[40:43]
    v_add_u32 v9, s51, v9
    v_mfma_f32_16x16x32_bf16 v[48:51], a[20:23], a[92:95], v[48:51]
    s_sub_u32 s51, 0, s51
    v_mfma_f32_16x16x32_bf16 v[56:59], a[20:23], a[96:99], v[56:59]
    v_mfma_f32_16x16x32_bf16 v[64:67], a[20:23], a[100:103], v[64:67]
    v_mfma_f32_16x16x32_bf16 v[72:75], a[20:23], a[104:107], v[72:75]
    v_mfma_f32_16x16x32_bf16 v[80:83], a[20:23], a[108:111], v[80:83]
    v_mfma_f32_16x16x32_bf16 v[16:19], a[24:27], a[80:83], v[16:19]
    s_add_u32 s49, s49, 1
    s_cmp_eq_u32 s49, 7
    v_mfma_f32_16x16x32_bf16 v[24:27], a[24:27], a[84:87], v[24:27]
    s_cselect_b32 s49, 0, s49
    s_addc_u32 s50, s50, 0
    v_mfma_f32_16x16x32_bf16 v[32:35], a[24:27], a[88:91], v[32:35]
    s_and_b32 s37, s50, 1
    v_mfma_f32_16x16x32_bf16 v[40:43], a[24:27], a[92:95], v[40:43]
    s_mul_i32 s37, s37, 61952
    s_add_u32 s37, s37, s41
    v_mfma_f32_16x16x32_bf16 v[48:51], a[24:27], a[96:99], v[48:51]
    v_add_u32 v4, s49, v2
    v_lshrrev_b32 v5, 1, v4
    v_mfma_f32_16x16x32_bf16 v[56:59], a[24:27], a[100:103], v[56:59]
    v_and_b32 v5, 2, v5
    v_mfma_f32_16x16x32_bf16 v[64:67], a[24:27], a[104:107], v[64:67]
    v_xor_b32 v5, v5, v3
    v_lshlrev_b32 v5, 4, v5
    v_mfma_f32_16x16x32_bf16 v[72:75], a[24:27], a[108:111], v[72:75]
    v_lshl_add_u32 v5, v4, 6, v5
    v_add_u32 v12, s37, v5
    v_mfma_f32_16x16x32_bf16 v[80:83], a[24:27], a[112:115], v[80:83]
    v_add_u32 v11, s52, v12
    s_branch L_p1
.p2align 6
L_loop:
    s_waitcnt lgkmcnt(7)
    v_mfma_f32_16x16x32_bf16 v[16:19], a[0:3], a[56:59], v[16:19]
    ds_read_b64_tr_b16 a[28:29], v9 offset:0
    v_mfma_f32_16x16x32_bf16 v[16:19], a[4:7], a[60:63], v[16:19]
    ds_read_b64_tr_b16 a[30:31], v9 offset:512
    v_mfma_f32_16x16x32_bf16 v[16:19], a[8:11], a[64:67], v[16:19]
    ds_read_b64_tr_b16 a[32:33], v9 offset:2048
    v_mfma_f32_16x16x32_bf16 v[16:19], a[12:15], a[68:71], v[16:19]
    ds_read_b64_tr_b16 a[34:35], v9 offset:2560
    v_mfma_f32_16x16x32_bf16 v[16:19], a[16:19], a[72:75], v[16:19]
    ds_read_b64_tr_b16 a[36:37], v9 offset:4096
    v_mfma_f32_16x16x32_bf16 v[16:19], a[20:23], a[76:79], v[16:19]
    ds_read_b64_tr_b16 a[38:39], v9 offset:4608
    v_mfma_f32_16x16x32_bf16 v[16:19], a[24:27], a[80:83], v[16:19]
    ds_read_b64_tr_b16 a[40:41], v9 offset:6144
    v_mfma_f32_16x16x32_bf16 v[24:27], a[24:27], a[84:87], v[24:27]
    ds_read_b64_tr_b16 a[42:43], v9 offset:6656
    v_mfma_f32_16x16x32_bf16 v[24:27], a[20:23], a[80:83], v[24:27]
    ds_read_b64_tr_b16 a[44:45], v9 offset:8192
    v_mfma_f32_16x16x32_bf16 v[24:27], a[16:19], a[76:79], v[24:27]
    ds_read_b64_tr_b16 a[46:47], v9 offset:8704
    v_mfma_f32_16x16x32_bf16 v[24:27], a[12:15], a[72:75], v[24:27]
    ds_read_b64_tr_b16 a[48:49], v9 offset:10240
    v_mfma_f32_16x16x32_bf16 v[24:27], a[8:11], a[68:71], v[24:27]
    ds_read_b64_tr_b16 a[50:51], v9 offset:10752
    v_mfma_f32_16x16x32_bf16 v[24:27], a[4:7], a[64:67], v[24:27]
    ds_read_b64_tr_b16 a[52:53], v9 offset:12288
    v_mfma_f32_16x16x32_bf16 v[24:27], a[0:3], a[60:63], v[24:27]
    ds_read_b64_tr_b16 a[54:55], v9 offset:12800
    v_mfma_f32_16x16x32_bf16 v[32:35], a[0:3], a[64:67], v[32:35]
    v_mfma_f32_16x16x32_bf16 v[32:35], a[4:7], a[68:71], v[32:35]
    v_mfma_f32_16x16x32_bf16 v[32:35], a[8:11], a[72:75], v[32:35]
    v_add_u32 v8, s51, v8
    v_mfma_f32_16x16x32_bf16 v[32:35], a[12:15], a[76:79], v[32:35]
    v_add_u32 v9, s51, v9
    v_mfma_f32_16x16x32_bf16 v[32:35], a[16:19], a[80:83], v[32:35]
    s_sub_u32 s51, 0, s51
    v_mfma_f32_16x16x32_bf16 v[32:35], a[20:23], a[84:87], v[32:35]
    s_waitcnt lgkmcnt(3)
    v_mfma_f32_16x16x32_bf16 v[32:35], a[24:27], a[88:91], v[32:35]
    s_add_u32 s49, s49, 1
    v_mfma_f32_16x16x32_bf16 v[40:43], a[24:27], a[92:95], v[40:43]
    s_cmp_eq_u32 s49, 7
    v_mfma_f32_16x16x32_bf16 v[40:43], a[20:23], a[88:91], v[40:43]
    s_cselect_b32 s49, 0, s49
    v_mfma_f32_16x16x32_bf16 v[40:43], a[16:19], a[84:87], v[40:43]
    s_addc_u32 s50, s50, 0
    v_mfma_f32_16x16x32_bf16 v[40:43], a[12:15], a[80:83], v[40:43]
    s_and_b32 s37, s50, 1
    v_mfma_f32_16x16x32_bf16 v[40:43], a[8:11], a[76:79], v[40:43]
    s_mul_i32 s37, s37, 61952
    v_mfma_f32_16x16x32_bf16 v[40:43], a[4:7], a[72:75], v[40:43]
    s_add_u32 s37, s37, s41
    v_mfma_f32_16x16x32_bf16 v[40:43], a[0:3], a[68:71], v[40:43]
    v_add_u32 v4, s49, v2
    v_mfma_f32_16x16x32_bf16 v[48:51], a[0:3], a[72:75], v[48:51]
    v_lshrrev_b32 v5, 1, v4
    v_mfma_f32_16x16x32_bf16 v[48:51], a[4:7], a[76:79], v[48:51]
    v_and_b32 v5, 2, v5
    v_mfma_f32_16x16x32_bf16 v[48:51], a[8:11], a[80:83], v[48:51]
    v_xor_b32 v5, v5, v3
    v_mfma_f32_16x16x32_bf16 v[48:51], a[12:15], a[84:87], v[48:51]
    v_lshlrev_b32 v5, 4, v5
    v_mfma_f32_16x16x32_bf16 v[48:51], a[16:19], a[88:91], v[48:51]
    v_lshl_add_u32 v5, v4, 6, v5
    v_mfma_f32_16x16x32_bf16 v[48:51], a[20:23], a[92:95], v[48:51]
    v_add_u32 v12, s37, v5
    v_mfma_f32_16x16x32_bf16 v[48:51], a[24:27], a[96:99], v[48:51]
    v_add_u32 v11, s52, v12
    v_mfma_f32_16x16x32_bf16 v[56:59], a[24:27], a[100:103], v[56:59]
    v_mfma_f32_16x16x32_bf16 v[56:59], a[20:23], a[96:99], v[56:59]
    v_mfma_f32_16x16x32_bf16 v[56:59], a[16:19], a[92:95], v[56:59]
    v_mfma_f32_16x16x32_bf16 v[56:59], a[12:15], a[88:91], v[56:59]
    v_mfma_f32_16x16x32_bf16 v[56:59], a[8:11], a[84:87], v[56:59]
    v_mfma_f32_16x16x32_bf16 v[56:59], a[4:7], a[80:83], v[56:59]
    v_mfma_f32_16x16x32_bf16 v[56:59], a[0:3], a[76:79], v[56:59]
    v_mfma_f32_16x16x32_bf16 v[64:67], a[0:3], a[80:83], v[64:67]
    v_mfma_f32_16x16x32_bf16 v[64:67], a[4:7], a[84:87], v[64:67]
    v_mfma_f32_16x16x32_bf16 v[64:67], a[8:11], a[88:91], v[64:67]
    v_mfma_f32_16x16x32_bf16 v[64:67], a[12:15], a[92:95], v[64:67]
    v_mfma_f32_16x16x32_bf16 v[64:67], a[16:19], a[96:99], v[64:67]
    v_mfma_f32_16x16x32_bf16 v[64:67], a[20:23], a[100:103], v[64:67]
    v_mfma_f32_16x16x32_bf16 v[64:67], a[24:27], a[104:107], v[64:67]
    v_mfma_f32_16x16x32_bf16 v[72:75], a[24:27], a[108:111], v[72:75]
    v_mfma_f32_16x16x32_bf16 v[72:75], a[20:23], a[104:107], v[72:75]
    v_mfma_f32_16x16x32_bf16 v[72:75], a[16:19], a[100:103], v[72:75]
    v_mfma_f32_16x16x32_bf16 v[72:75], a[12:15], a[96:99], v[72:75]
    v_mfma_f32_16x16x32_bf16 v[72:75], a[8:11], a[92:95], v[72:75]
    v_mfma_f32_16x16x32_bf16 v[72:75], a[4:7], a[88:91], v[72:75]
    v_mfma_f32_16x16x32_bf16 v[72:75], a[0:3], a[84:87], v[72:75]
    v_mfma_f32_16x16x32_bf16 v[80:83], a[0:3], a[88:91], v[80:83]
    v_mfma_f32_16x16x32_bf16 v[80:83], a[4:7], a[92:95], v[80:83]
    v_mfma_f32_16x16x32_bf16 v[80:83], a[8:11], a[96:99], v[80:83]
    v_mfma_f32_16x16x32_bf16 v[80:83], a[12:15], a[100:103], v[80:83]
    v_mfma_f32_16x16x32_bf16 v[80:83], a[16:19], a[104:107], v[80:83]
    v_mfma_f32_16x16x32_bf16 v[80:83], a[20:23], a[108:111], v[80:83]
    v_mfma_f32_16x16x32_bf16 v[80:83], a[24:27], a[112:115], v[80:83]
L_p1:
    s_waitcnt vmcnt(0) lgkmcnt(0)
    s_cmp_eq_u32 s47, 0
    s_barrier
    s_cbranch_scc1 L_noxa
    v_mfma_f32_16x16x32_bf16 v[88:91], a[28:31], a[116:119], v[88:91]
    ds_read_b128 a[116:119], v12 offset:0
    v_mfma_f32_16x16x32_bf16 v[88:91], a[32:35], a[120:123], v[88:91]
    ds_read_b128 a[120:123], v12 offset:1408
    v_mfma_f32_16x16x32_bf16 v[88:91], a[36:39], a[124:127], v[88:91]
    ds_read_b128 a[124:127], v12 offset:2816
    v_mfma_f32_16x16x32_bf16 v[88:91], a[40:43], a[128:131], v[88:91]
    ds_read_b128 a[128:131], v12 offset:4224
    v_mfma_f32_16x16x32_bf16 v[88:91], a[44:47], a[132:135], v[88:91]
    ds_read_b128 a[132:135], v12 offset:5632
    v_mfma_f32_16x16x32_bf16 v[88:91], a[48:51], a[136:139], v[88:91]
    ds_read_b128 a[136:139], v12 offset:7040
    v_mfma_f32_16x16x32_bf16 v[88:91], a[52:55], a[140:143], v[88:91]
    ds_read_b128 a[140:143], v12 offset:8448
L_noxa:
    v_mfma_f32_16x16x32_bf16 v[20:23], a[28:31], a[56:59], v[20:23]
    ds_read_b128 a[56:59], v11 offset:0
    v_mfma_f32_16x16x32_bf16 v[20:23], a[32:35], a[60:63], v[20:23]
    ds_read_b64_tr_b16 a[0:1], v8 offset:0
    v_mfma_f32_16x16x32_bf16 v[20:23], a[36:39], a[64:67], v[20:23]
    ds_read_b64_tr_b16 a[2:3], v8 offset:512
    v_mfma_f32_16x16x32_bf16 v[20:23], a[40:43], a[68:71], v[20:23]
    ds_read_b64_tr_b16 a[4:5], v8 offset:2048
    v_mfma_f32_16x16x32_bf16 v[20:23], a[44:47], a[72:75], v[20:23]
    ds_read_b64_tr_b16 a[6:7], v8 offset:2560
    v_mfma_f32_16x16x32_bf16 v[20:23], a[48:51], a[76:79], v[20:23]
    ds_read_b64_tr_b16 a[8:9], v8 offset:4096
    v_mfma_f32_16x16x32_bf16 v[20:23], a[52:55], a[80:83], v[20:23]
    ds_read_b64_tr_b16 a[10:11], v8 offset:4608
    v_mfma_f32_16x16x32_bf16 v[28:31], a[28:31], a[60:63], v[28:31]
    ds_read_b128 a[60:63], v11 offset:1408
    v_mfma_f32_16x16x32_bf16 v[28:31], a[32:35], a[64:67], v[28:31]
    ds_read_b64_tr_b16 a[12:13], v8 offset:6144
    v_mfma_f32_16x16x32_bf16 v[28:31], a[36:39], a[68:71], v[28:31]
    ds_read_b64_tr_b16 a[14:15], v8 offset:6656
    v_mfma_f32_16x16x32_bf16 v[28:31], a[40:43], a[72:75], v[28:31]
    ds_read_b64_tr_b16 a[16:17], v8 offset:8192
    v_mfma_f32_16x16x32_bf16 v[28:31], a[44:47], a[76:79], v[28:31]
    ds_read_b64_tr_b16 a[18:19], v8 offset:8704
    v_mfma_f32_16x16x32_bf16 v[28:31], a[48:51], a[80:83], v[28:31]
    ds_read_b64_tr_b16 a[20:21], v8 offset:10240
    v_mfma_f32_16x16x32_bf16 v[28:31], a[52:55], a[84:87], v[28:31]
    ds_read_b64_tr_b16 a[22:23], v8 offset:10752
    v_mfma_f32_16x16x32_bf16 v[36:39], a[28:31], a[64:67], v[36:39]
    ds_read_b128 a[64:67], v11 offset:2816
    v_mfma_f32_16x16x32_bf16 v[36:39], a[32:35], a[68:71], v[36:39]
    ds_read_b64_tr_b16 a[24:25], v8 offset:12288
    v_mfma_f32_16x16x32_bf16 v[36:39], a[36:39], a[72:75], v[36:39]
    ds_read_b64_tr_b16 a[26:27], v8 offset:12800
    v_mfma_f32_16x16x32_bf16 v[36:39], a[40:43], a[76:79], v[36:39]
    v_mfma_f32_16x16x32_bf16 v[36:39], a[44:47], a[80:83], v[36:39]
    v_mfma_f32_16x16x32_bf16 v[36:39], a[48:51], a[84:87], v[36:39]
    v_mfma_f32_16x16x32_bf16 v[36:39], a[52:55], a[88:91], v[36:39]
    v_mfma_f32_16x16x32_bf16 v[44:47], a[28:31], a[68:71], v[44:47]
    ds_read_b128 a[68:71], v11 offset:4224
    v_mfma_f32_16x16x32_bf16 v[44:47], a[32:35], a[72:75], v[44:47]
    v_mfma_f32_16x16x32_bf16 v[44:47], a[36:39], a[76:79], v[44:47]
    v_mfma_f32_16x16x32_bf16 v[44:47], a[40:43], a[80:83], v[44:47]
    v_mfma_f32_16x16x32_bf16 v[44:47], a[44:47], a[84:87], v[44:47]
    v_mfma_f32_16x16x32_bf16 v[44:47], a[48:51], a[88:91], v[44:47]
    v_mfma_f32_16x16x32_bf16 v[44:47], a[52:55], a[92:95], v[44:47]
    v_mfma_f32_16x16x32_bf16 v[52:55], a[28:31], a[72:75], v[52:55]
    ds_read_b128 a[72:75], v11 offset:5632
    v_mfma_f32_16x16x32_bf16 v[52:55], a[32:35], a[76:79], v[52:55]
    v_mfma_f32_16x16x32_bf16 v[52:55], a[36:39], a[80:83], v[52:55]
    v_mfma_f32_16x16x32_bf16 v[52:55], a[40:43], a[84:87], v[52:55]
    v_mfma_f32_16x16x32_bf16 v[52:55], a[44:47], a[88:91], v[52:55]
    v_mfma_f32_16x16x32_bf16 v[52:55], a[48:51], a[92:95], v[52:55]
    v_mfma_f32_16x16x32_bf16 v[52:55], a[52:55], a[96:99], v[52:55]
    v_mfma_f32_16x16x32_bf16 v[60:63], a[28:31], a[76:79], v[60:63]
    ds_read_b128 a[76:79], v11 offset:7040
    v_mfma_f32_16x16x32_bf16 v[60:63], a[32:35], a[80:83], v[60:63]
    v_mfma_f32_16x16x32_bf16 v[60:63], a[36:39], a[84:87], v[60:63]
    v_mfma_f32_16x16x32_bf16 v[60:63], a[40:43], a[88:91], v[60:63]
    v_mfma_f32_16x16x32_bf16 v[60:63], a[44:47], a[92:95], v[60:63]
    v_mfma_f32_16x16x32_bf16 v[60:63], a[48:51], a[96:99], v[60:63]
    v_mfma_f32_16x16x32_bf16 v[60:63], a[52:55], a[100:103], v[60:63]
    v_mfma_f32_16x16x32_bf16 v[68:71], a[28:31], a[80:83], v[68:71]
    ds_read_b128 a[80:83], v11 offset:8448
    v_mfma_f32_16x16x32_bf16 v[68:71], a[32:35], a[84:87], v[68:71]
    v_mfma_f32_16x16x32_bf16 v[68:71], a[36:39], a[88:91], v[68:71]
    v_mfma_f32_16x16x32_bf16 v[68:71], a[40:43], a[92:95], v[68:71]
    v_mfma_f32_16x16x32_bf16 v[68:71], a[44:47], a[96:99], v[68:71]
    v_mfma_f32_16x16x32_bf16 v[68:71], a[48:51], a[100:103], v[68:71]
    v_mfma_f32_16x16x32_bf16 v[68:71], a[52:55], a[104:107], v[68:71]
    v_mfma_f32_16x16x32_bf16 v[76:79], a[28:31], a[84:87], v[76:79]
    ds_read_b128 a[84:87], v11 offset:9856
    v_mfma_f32_16x16x32_bf16 v[76:79], a[32:35], a[88:91], v[76:79]
    v_mfma_f32_16x16x32_bf16 v[76:79], a[36:39], a[92:95], v[76:79]
    v_mfma_f32_16x16x32_bf16 v[76:79], a[40:43], a[96:99], v[76:79]
    s_add_u32 s48, s48, 1
    v_mfma_f32_16x16x32_bf16 v[76:79], a[44:47], a[100:103], v[76:79]
    s_cmp_lt_u32 s48, 20
    v_mfma_f32_16x16x32_bf16 v[76:79], a[48:51], a[104:107], v[76:79]
    v_mfma_f32_16x16x32_bf16 v[76:79], a[52:55], a[108:111], v[76:79]
    v_mfma_f32_16x16x32_bf16 v[84:87], a[28:31], a[88:91], v[84:87]
    ds_read_b128 a[88:91], v11 offset:11264
    v_mfma_f32_16x16x32_bf16 v[84:87], a[32:35], a[92:95], v[84:87]
    ds_read_b128 a[92:95], v11 offset:12672
    v_mfma_f32_16x16x32_bf16 v[84:87], a[36:39], a[96:99], v[84:87]
    ds_read_b128 a[96:99], v11 offset:14080
    v_mfma_f32_16x16x32_bf16 v[84:87], a[40:43], a[100:103], v[84:87]
    ds_read_b128 a[100:103], v11 offset:15488
    v_mfma_f32_16x16x32_bf16 v[84:87], a[44:47], a[104:107], v[84:87]
    ds_read_b128 a[104:107], v11 offset:16896
    v_mfma_f32_16x16x32_bf16 v[84:87], a[48:51], a[108:111], v[84:87]
    ds_read_b128 a[108:111], v11 offset:18304
    v_mfma_f32_16x16x32_bf16 v[84:87], a[52:55], a[112:115], v[84:87]
    ds_read_b128 a[112:115], v11 offset:19712
    s_cbranch_scc1 L_loop
    s_waitcnt lgkmcnt(7)
    v_mfma_f32_16x16x32_bf16 v[16:19], a[0:3], a[56:59], v[16:19]
    ds_read_b64_tr_b16 a[28:29], v9 offset:0
    ds_read_b64_tr_b16 a[30:31], v9 offset:512
    v_mfma_f32_16x16x32_bf16 v[16:19], a[4:7], a[60:63], v[16:19]
    ds_read_b64_tr_b16 a[32:33], v9 offset:2048
    ds_read_b64_tr_b16 a[34:35], v9 offset:2560
    v_mfma_f32_16x16x32_bf16 v[16:19], a[8:11], a[64:67], v[16:19]
    ds_read_b64_tr_b16 a[36:37], v9 offset:4096
    ds_read_b64_tr_b16 a[38:39], v9 offset:4608
    v_mfma_f32_16x16x32_bf16 v[16:19], a[12:15], a[68:71], v[16:19]
    ds_read_b64_tr_b16 a[40:41], v9 offset:6144
    ds_read_b64_tr_b16 a[42:43], v9 offset:6656
    v_mfma_f32_16x16x32_bf16 v[16:19], a[16:19], a[72:75], v[16:19]
    ds_read_b64_tr_b16 a[44:45], v9 offset:8192
    ds_read_b64_tr_b16 a[46:47], v9 offset:8704
    v_mfma_f32_16x16x32_bf16 v[16:19], a[20:23], a[76:79], v[16:19]
    ds_read_b64_tr_b16 a[48:49], v9 offset:10240
    ds_read_b64_tr_b16 a[50:51], v9 offset:10752
    v_mfma_f32_16x16x32_bf16 v[16:19], a[24:27], a[80:83], v[16:19]
    ds_read_b64_tr_b16 a[52:53], v9 offset:12288
    ds_read_b64_tr_b16 a[54:55], v9 offset:12800
    v_mfma_f32_16x16x32_bf16 v[24:27], a[0:3], a[60:63], v[24:27]
    v_mfma_f32_16x16x32_bf16 v[24:27], a[4:7], a[64:67], v[24:27]
    v_mfma_f32_16x16x32_bf16 v[24:27], a[8:11], a[68:71], v[24:27]
    v_mfma_f32_16x16x32_bf16 v[24:27], a[12:15], a[72:75], v[24:27]
    v_mfma_f32_16x16x32_bf16 v[24:27], a[16:19], a[76:79], v[24:27]
    v_mfma_f32_16x16x32_bf16 v[24:27], a[20:23], a[80:83], v[24:27]
    v_mfma_f32_16x16x32_bf16 v[24:27], a[24:27], a[84:87], v[24:27]
    s_waitcnt lgkmcnt(4)
    v_mfma_f32_16x16x32_bf16 v[20:23], a[28:31], a[56:59], v[20:23]
    v_and_b32 v4, 1, v3
    v_lshlrev_b32 v4, 5, v4
    v_xor_b32 v4, s93, v4
    v_mfma_f32_16x16x32_bf16 v[20:23], a[32:35], a[60:63], v[20:23]
    v_lshrrev_b32 v5, 1, v3
    v_lshl_add_u32 v4, v5, 4, v4
    v_mul_u32_u24 v5, 384, v2
    v_mfma_f32_16x16x32_bf16 v[20:23], a[36:39], a[64:67], v[20:23]
    v_add_u32 v14, v4, v5
    s_mul_i32 s60, s24, 9
    v_mfma_f32_16x16x32_bf16 v[20:23], a[40:43], a[68:71], v[20:23]
    s_add_u32 s60, s60, s34
    s_mul_i32 s60, s60, 86016
    s_add_u32 s60, s60, s32
    v_mfma_f32_16x16x32_bf16 v[20:23], a[44:47], a[72:75], v[20:23]
    s_mul_i32 s37, s33, 6144
    s_add_u32 s60, s60, s37
    s_add_u32 s60, s60, s25
    s_waitcnt lgkmcnt(0)
    v_mfma_f32_16x16x32_bf16 v[20:23], a[48:51], a[76:79], v[20:23]
    v_lshl_add_u32 v5, v3, 3, v5
    v_add_u32 v12, s94, v5
    v_mfma_f32_16x16x32_bf16 v[20:23], a[52:55], a[80:83], v[20:23]
    s_add_u32 s39, s35, s34
    s_mul_i32 s39, s39, 86016
    s_add_u32 s39, s39, s32
    v_mfma_f32_16x16x32_bf16 v[28:31], a[28:31], a[60:63], v[28:31]
    s_add_u32 s39, s39, s37
    s_add_u32 s39, s39, s25
    v_mfma_f32_16x16x32_bf16 v[28:31], a[32:35], a[64:67], v[28:31]
    v_mfma_f32_16x16x32_bf16 v[28:31], a[36:39], a[68:71], v[28:31]
    v_mfma_f32_16x16x32_bf16 v[28:31], a[40:43], a[72:75], v[28:31]
    v_cvt_pk_bf16_f32 v4, v16, v17
    v_mfma_f32_16x16x32_bf16 v[28:31], a[44:47], a[76:79], v[28:31]
    v_cvt_pk_bf16_f32 v5, v18, v19
    v_mfma_f32_16x16x32_bf16 v[28:31], a[48:51], a[80:83], v[28:31]
    v_cvt_pk_bf16_f32 v6, v20, v21
    v_mfma_f32_16x16x32_bf16 v[28:31], a[52:55], a[84:87], v[28:31]
    v_cvt_pk_bf16_f32 v7, v22, v23
    s_cmp_eq_u32 s47, 0
    s_cbranch_scc1 L_noxb
    v_mfma_f32_16x16x32_bf16 v[88:91], a[28:31], a[116:119], v[88:91]
    v_mfma_f32_16x16x32_bf16 v[88:91], a[32:35], a[120:123], v[88:91]
    v_mfma_f32_16x16x32_bf16 v[88:91], a[36:39], a[124:127], v[88:91]
    v_mfma_f32_16x16x32_bf16 v[88:91], a[40:43], a[128:131], v[88:91]
    v_mfma_f32_16x16x32_bf16 v[88:91], a[44:47], a[132:135], v[88:91]
    v_mfma_f32_16x16x32_bf16 v[88:91], a[48:51], a[136:139], v[88:91]
    v_mfma_f32_16x16x32_bf16 v[88:91], a[52:55], a[140:143], v[88:91]
L_noxb:
    v_mfma_f32_16x16x32_bf16 v[32:35], a[0:3], a[64:67], v[32:35]
    s_add_u32 s62, s60, 0
    v_mfma_f32_16x16x32_bf16 v[32:35], a[4:7], a[68:71], v[32:35]
    s_nop 0
    v_mfma_f32_16x16x32_bf16 v[32:35], a[8:11], a[72:75], v[32:35]
    v_permlane16_swap_b32 v4, v6
    v_mfma_f32_16x16x32_bf16 v[32:35], a[12:15], a[76:79], v[32:35]
    v_permlane16_swap_b32 v5, v7
    v_mfma_f32_16x16x32_bf16 v[32:35], a[16:19], a[80:83], v[32:35]
    buffer_store_dwordx4 v[4:7], v14, s[20:23], s62 offen sc1
    v_mfma_f32_16x16x32_bf16 v[32:35], a[20:23], a[84:87], v[32:35]
    v_mfma_f32_16x16x32_bf16 v[32:35], a[24:27], a[88:91], v[32:35]
    v_mfma_f32_16x16x32_bf16 v[36:39], a[28:31], a[64:67], v[36:39]
    v_cvt_pk_bf16_f32 v4, v24, v25
    v_mfma_f32_16x16x32_bf16 v[36:39], a[32:35], a[68:71], v[36:39]
    v_cvt_pk_bf16_f32 v5, v26, v27
    v_mfma_f32_16x16x32_bf16 v[36:39], a[36:39], a[72:75], v[36:39]
    v_cvt_pk_bf16_f32 v6, v28, v29
    v_mfma_f32_16x16x32_bf16 v[36:39], a[40:43], a[76:79], v[36:39]
    v_cvt_pk_bf16_f32 v7, v30, v31
    v_mfma_f32_16x16x32_bf16 v[36:39], a[44:47], a[80:83], v[36:39]
    s_add_u32 s62, s60, 86016
    v_mfma_f32_16x16x32_bf16 v[36:39], a[48:51], a[84:87], v[36:39]
    s_nop 0
    v_mfma_f32_16x16x32_bf16 v[36:39], a[52:55], a[88:91], v[36:39]
    v_permlane16_swap_b32 v4, v6
    v_mfma_f32_16x16x32_bf16 v[40:43], a[0:3], a[68:71], v[40:43]
    v_permlane16_swap_b32 v5, v7
    v_mfma_f32_16x16x32_bf16 v[40:43], a[4:7], a[72:75], v[40:43]
    buffer_store_dwordx4 v[4:7], v14, s[20:23], s62 offen sc1
    v_mfma_f32_16x16x32_bf16 v[40:43], a[8:11], a[76:79], v[40:43]
    v_mfma_f32_16x16x32_bf16 v[40:43], a[12:15], a[80:83], v[40:43]
    v_mfma_f32_16x16x32_bf16 v[40:43], a[16:19], a[84:87], v[40:43]
    v_cvt_pk_bf16_f32 v4, v32, v33
    v_mfma_f32_16x16x32_bf16 v[40:43], a[20:23], a[88:91], v[40:43]
    v_cvt_pk_bf16_f32 v5, v34, v35
    v_mfma_f32_16x16x32_bf16 v[40:43], a[24:27], a[92:95], v[40:43]
    v_cvt_pk_bf16_f32 v6, v36, v37
    v_mfma_f32_16x16x32_bf16 v[44:47], a[28:31], a[68:71], v[44:47]
    v_cvt_pk_bf16_f32 v7, v38, v39
    v_mfma_f32_16x16x32_bf16 v[44:47], a[32:35], a[72:75], v[44:47]
    s_add_u32 s62, s60, 172032
    v_mfma_f32_16x16x32_bf16 v[44:47], a[36:39], a[76:79], v[44:47]
    s_nop 0
    v_mfma_f32_16x16x32_bf16 v[44:47], a[40:43], a[80:83], v[44:47]
    v_permlane16_swap_b32 v4, v6
    v_mfma_f32_16x16x32_bf16 v[44:47], a[44:47], a[84:87], v[44:47]
    v_permlane16_swap_b32 v5, v7
    v_mfma_f32_16x16x32_bf16 v[44:47], a[48:51], a[88:91], v[44:47]
    buffer_store_dwordx4 v[4:7], v14, s[20:23], s62 offen sc1
    s_cmp_eq_u32 s47, 0
    s_cbranch_scc1 L_noxs
    v_cvt_pk_bf16_f32 v4, v88, v89
    v_cvt_pk_bf16_f32 v5, v90, v91
    buffer_store_dwordx2 v[4:5], v12, s[20:23], s39 offen
L_noxs:
    v_mfma_f32_16x16x32_bf16 v[44:47], a[52:55], a[92:95], v[44:47]
    v_mfma_f32_16x16x32_bf16 v[48:51], a[0:3], a[72:75], v[48:51]
    v_mfma_f32_16x16x32_bf16 v[48:51], a[4:7], a[76:79], v[48:51]
    v_mfma_f32_16x16x32_bf16 v[48:51], a[8:11], a[80:83], v[48:51]
    v_mfma_f32_16x16x32_bf16 v[48:51], a[12:15], a[84:87], v[48:51]
    v_cvt_pk_bf16_f32 v4, v40, v41
    v_mfma_f32_16x16x32_bf16 v[48:51], a[16:19], a[88:91], v[48:51]
    v_cvt_pk_bf16_f32 v5, v42, v43
    v_mfma_f32_16x16x32_bf16 v[48:51], a[20:23], a[92:95], v[48:51]
    v_cvt_pk_bf16_f32 v6, v44, v45
    v_mfma_f32_16x16x32_bf16 v[48:51], a[24:27], a[96:99], v[48:51]
    v_cvt_pk_bf16_f32 v7, v46, v47
    v_mfma_f32_16x16x32_bf16 v[52:55], a[28:31], a[72:75], v[52:55]
    s_add_u32 s62, s60, 258048
    v_mfma_f32_16x16x32_bf16 v[52:55], a[32:35], a[76:79], v[52:55]
    s_nop 0
    v_mfma_f32_16x16x32_bf16 v[52:55], a[36:39], a[80:83], v[52:55]
    v_permlane16_swap_b32 v4, v6
    v_mfma_f32_16x16x32_bf16 v[52:55], a[40:43], a[84:87], v[52:55]
    v_permlane16_swap_b32 v5, v7
    v_mfma_f32_16x16x32_bf16 v[52:55], a[44:47], a[88:91], v[52:55]
    buffer_store_dwordx4 v[4:7], v14, s[20:23], s62 offen sc1
    v_mfma_f32_16x16x32_bf16 v[52:55], a[48:51], a[92:95], v[52:55]
    v_mfma_f32_16x16x32_bf16 v[52:55], a[52:55], a[96:99], v[52:55]
    v_mfma_f32_16x16x32_bf16 v[56:59], a[0:3], a[76:79], v[56:59]
    v_mfma_f32_16x16x32_bf16 v[56:59], a[4:7], a[80:83], v[56:59]
    v_mfma_f32_16x16x32_bf16 v[56:59], a[8:11], a[84:87], v[56:59]
    v_mfma_f32_16x16x32_bf16 v[56:59], a[12:15], a[88:91], v[56:59]
    v_cvt_pk_bf16_f32 v4, v48, v49
    v_mfma_f32_16x16x32_bf16 v[56:59], a[16:19], a[92:95], v[56:59]
    v_cvt_pk_bf16_f32 v5, v50, v51
    v_mfma_f32_16x16x32_bf16 v[56:59], a[20:23], a[96:99], v[56:59]
    v_cvt_pk_bf16_f32 v6, v52, v53
    v_mfma_f32_16x16x32_bf16 v[56:59], a[24:27], a[100:103], v[56:59]
    v_cvt_pk_bf16_f32 v7, v54, v55
    v_mfma_f32_16x16x32_bf16 v[60:63], a[28:31], a[76:79], v[60:63]
    s_add_u32 s62, s60, 344064
    v_mfma_f32_16x16x32_bf16 v[60:63], a[32:35], a[80:83], v[60:63]
    s_nop 0
    v_mfma_f32_16x16x32_bf16 v[60:63], a[36:39], a[84:87], v[60:63]
    v_permlane16_swap_b32 v4, v6
    v_mfma_f32_16x16x32_bf16 v[60:63], a[40:43], a[88:91], v[60:63]
    v_permlane16_swap_b32 v5, v7
    v_mfma_f32_16x16x32_bf16 v[60:63], a[44:47], a[92:95], v[60:63]
    buffer_store_dwordx4 v[4:7], v14, s[20:23], s62 offen sc1
    v_mfma_f32_16x16x32_bf16 v[60:63], a[48:51], a[96:99], v[60:63]
    v_mfma_f32_16x16x32_bf16 v[60:63], a[52:55], a[100:103], v[60:63]
    v_mfma_f32_16x16x32_bf16 v[64:67], a[0:3], a[80:83], v[64:67]
    v_mfma_f32_16x16x32_bf16 v[64:67], a[4:7], a[84:87], v[64:67]
    v_mfma_f32_16x16x32_bf16 v[64:67], a[8:11], a[88:91], v[64:67]
    v_mfma_f32_16x16x32_bf16 v[64:67], a[12:15], a[92:95], v[64:67]
    v_cvt_pk_bf16_f32 v4, v56, v57
    v_mfma_f32_16x16x32_bf16 v[64:67], a[16:19], a[96:99], v[64:67]
    v_cvt_pk_bf16_f32 v5, v58, v59
    v_mfma_f32_16x16x32_bf16 v[64:67], a[20:23], a[100:103], v[64:67]
    v_cvt_pk_bf16_f32 v6, v60, v61
    v_mfma_f32_16x16x32_bf16 v[64:67], a[24:27], a[104:107], v[64:67]
    v_cvt_pk_bf16_f32 v7, v62, v63
    v_mfma_f32_16x16x32_bf16 v[68:71], a[28:31], a[80:83], v[68:71]
    s_add_u32 s62, s60, 430080
    v_mfma_f32_16x16x32_bf16 v[68:71], a[32:35], a[84:87], v[68:71]
    s_nop 0
    v_mfma_f32_16x16x32_bf16 v[68:71], a[36:39], a[88:91], v[68:71]
    v_permlane16_swap_b32 v4, v6
    v_mfma_f32_16x16x32_bf16 v[68:71], a[40:43], a[92:95], v[68:71]
    v_permlane16_swap_b32 v5, v7
    v_mfma_f32_16x16x32_bf16 v[68:71], a[44:47], a[96:99], v[68:71]
    buffer_store_dwordx4 v[4:7], v14, s[20:23], s62 offen sc1
    v_mfma_f32_16x16x32_bf16 v[68:71], a[48:51], a[100:103], v[68:71]
    v_mfma_f32_16x16x32_bf16 v[68:71], a[52:55], a[104:107], v[68:71]
    v_mfma_f32_16x16x32_bf16 v[72:75], a[0:3], a[84:87], v[72:75]
    v_mfma_f32_16x16x32_bf16 v[72:75], a[4:7], a[88:91], v[72:75]
    v_mfma_f32_16x16x32_bf16 v[72:75], a[8:11], a[92:95], v[72:75]
    v_mfma_f32_16x16x32_bf16 v[72:75], a[12:15], a[96:99], v[72:75]
    v_cvt_pk_bf16_f32 v4, v64, v65
    v_mfma_f32_16x16x32_bf16 v[72:75], a[16:19], a[100:103], v[72:75]
    v_cvt_pk_bf16_f32 v5, v66, v67
    v_mfma_f32_16x16x32_bf16 v[72:75], a[20:23], a[104:107], v[72:75]
    v_cvt_pk_bf16_f32 v6, v68, v69
    v_mfma_f32_16x16x32_bf16 v[72:75], a[24:27], a[108:111], v[72:75]
    v_cvt_pk_bf16_f32 v7, v70, v71
    v_mfma_f32_16x16x32_bf16 v[76:79], a[28:31], a[84:87], v[76:79]
    s_add_u32 s62, s60, 516096
    v_mfma_f32_16x16x32_bf16 v[76:79], a[32:35], a[88:91], v[76:79]
    s_nop 0
    v_mfma_f32_16x16x32_bf16 v[76:79], a[36:39], a[92:95], v[76:79]
    v_permlane16_swap_b32 v4, v6
    v_mfma_f32_16x16x32_bf16 v[76:79], a[40:43], a[96:99], v[76:79]
    v_permlane16_swap_b32 v5, v7
    v_mfma_f32_16x16x32_bf16 v[76:79], a[44:47], a[100:103], v[76:79]
    buffer_store_dwordx4 v[4:7], v14, s[20:23], s62 offen sc1
    v_mfma_f32_16x16x32_bf16 v[76:79], a[48:51], a[104:107], v[76:79]
    v_mfma_f32_16x16x32_bf16 v[76:79], a[52:55], a[108:111], v[76:79]
    v_mfma_f32_16x16x32_bf16 v[80:83], a[0:3], a[88:91], v[80:83]
    v_mfma_f32_16x16x32_bf16 v[80:83], a[4:7], a[92:95], v[80:83]
    v_mfma_f32_16x16x32_bf16 v[80:83], a[8:11], a[96:99], v[80:83]
    v_mfma_f32_16x16x32_bf16 v[80:83], a[12:15], a[100:103], v[80:83]
    v_cvt_pk_bf16_f32 v4, v72, v73
    v_mfma_f32_16x16x32_bf16 v[80:83], a[16:19], a[104:107], v[80:83]
    v_cvt_pk_bf16_f32 v5, v74, v75
    v_mfma_f32_16x16x32_bf16 v[80:83], a[20:23], a[108:111], v[80:83]
    v_cvt_pk_bf16_f32 v6, v76, v77
    v_mfma_f32_16x16x32_bf16 v[80:83], a[24:27], a[112:115], v[80:83]
    v_cvt_pk_bf16_f32 v7, v78, v79
    v_mfma_f32_16x16x32_bf16 v[84:87], a[28:31], a[88:91], v[84:87]
    s_add_u32 s62, s60, 602112
    v_mfma_f32_16x16x32_bf16 v[84:87], a[32:35], a[92:95], v[84:87]
    s_nop 0
    v_mfma_f32_16x16x32_bf16 v[84:87], a[36:39], a[96:99], v[84:87]
    v_permlane16_swap_b32 v4, v6
    v_mfma_f32_16x16x32_bf16 v[84:87], a[40:43], a[100:103], v[84:87]
    v_permlane16_swap_b32 v5, v7
    v_mfma_f32_16x16x32_bf16 v[84:87], a[44:47], a[104:107], v[84:87]
    buffer_store_dwordx4 v[4:7], v14, s[20:23], s62 offen sc1
    v_mfma_f32_16x16x32_bf16 v[84:87], a[48:51], a[108:111], v[84:87]
    v_mfma_f32_16x16x32_bf16 v[84:87], a[52:55], a[112:115], v[84:87]
    s_nop 7
    v_cvt_pk_bf16_f32 v4, v80, v81
    v_cvt_pk_bf16_f32 v5, v82, v83
    v_cvt_pk_bf16_f32 v6, v84, v85
    v_cvt_pk_bf16_f32 v7, v86, v87
    s_add_u32 s62, s60, 688128
    s_nop 0
    v_permlane16_swap_b32 v4, v6
    v_permlane16_swap_b32 v5, v7
    buffer_store_dwordx4 v[4:7], v14, s[20:23], s62 offen sc1
    s_endpgm
L_loader:
    v_lshrrev_b32 v4, 2, v1
    v_and_b32 v5, 3, v4
    v_and_b32 v6, 4, v4
    v_lshl_or_b32 v5, v6, 1, v5
    v_and_b32 v7, 8, v4
    v_lshrrev_b32 v7, 1, v7
    v_or_b32 v5, v5, v7
    v_mul_u32_u24 v5, 192, v5
    v_lshrrev_b32 v6, 1, v6
    v_and_b32 v7, 3, v1
    v_xor_b32 v6, v6, v7
    v_lshl_add_u32 v5, v6, 4, v5
    v_add_u32 v20, s25, v5
    s_mov_b32 s53, 0
    s_mov_b32 s54, 123904
    s_waitcnt lgkmcnt(0)
    s_mov_b32 s12, s4
    s_and_b32 s13, s5, 0xffff
    s_mov_b32 s14, 9633792
    s_mov_b32 s15, 0x20000
    s_mov_b32 s16, s6
    s_and_b32 s17, s7, 0xffff
    s_mov_b32 s18, 903168
    s_mov_b32 s19, 0x20000
    s_add_u32 m0, s54, 0
    s_add_u32 s42, s53, 3072
    buffer_load_dwordx4 v20, s[16:19], s53 offen lds
    s_add_u32 m0, m0, 1024
    s_add_u32 s53, s53, 129024
    buffer_load_dwordx4 v20, s[16:19], s42 offen lds
    s_add_u32 m0, m0, 1024
    s_add_u32 s42, s53, 3072
    buffer_load_dwordx4 v20, s[16:19], s53 offen lds
    s_add_u32 m0, m0, 1024
    s_add_u32 s53, s53, 129024
    buffer_load_dwordx4 v20, s[16:19], s42 offen lds
    s_add_u32 m0, m0, 1024
    s_add_u32 s42, s53, 3072
    buffer_load_dwordx4 v20, s[16:19], s53 offen lds
    s_add_u32 m0, m0, 1024
    s_add_u32 s53, s53, 129024
    buffer_load_dwordx4 v20, s[16:19], s42 offen lds
    s_add_u32 m0, m0, 1024
    s_add_u32 s42, s53, 3072
    buffer_load_dwordx4 v20, s[16:19], s53 offen lds
    s_add_u32 m0, m0, 1024
    s_add_u32 s53, s53, 129024
    buffer_load_dwordx4 v20, s[16:19], s42 offen lds
    s_add_u32 m0, m0, 1024
    s_add_u32 s42, s53, 3072
    buffer_load_dwordx4 v20, s[16:19], s53 offen lds
    s_add_u32 m0, m0, 1024
    s_add_u32 s53, s53, 129024
    buffer_load_dwordx4 v20, s[16:19], s42 offen lds
    s_add_u32 m0, m0, 1024
    s_add_u32 s42, s53, 3072
    buffer_load_dwordx4 v20, s[16:19], s53 offen lds
    s_add_u32 m0, m0, 1024
    s_add_u32 s53, s53, 129024
    buffer_load_dwordx4 v20, s[16:19], s42 offen lds
    s_add_u32 m0, m0, 1024
    s_add_u32 s42, s53, 3072
    buffer_load_dwordx4 v20, s[16:19], s53 offen lds
    s_add_u32 m0, m0, 1024
    s_add_u32 s53, s53, 129024
    buffer_load_dwordx4 v20, s[16:19], s42 offen lds
    s_mov_b32 s48, 0
    s_mov_b32 s49, 1
    s_mov_b32 s50, 0
    s_mov_b32 s54, 138240
    s_mov_b32 s51, 4294952960
    s_mul_i32 s53, s49, 18432
    s_mul_i32 s37, s50, 6144
    s_add_u32 s53, s53, s37
    v_lshrrev_b32 v4, 2, v1
    v_lshrrev_b32 v5, 1, v4
    v_and_b32 v5, 2, v5
    v_and_b32 v6, 3, v1
    v_xor_b32 v5, v5, v6
    v_lshlrev_b32 v5, 4, v5
    v_bfrev_b32 v7, 1
    s_lshl_b32 s37, s33, 4
    s_add_u32 s37, s37, 4109
    s_sub_u32 s37, s37, 4096
    v_add_u32 v6, s37, v4
    v_mul_u32_u24 v17, 384, v6
    v_cmp_gt_u32 vcc, 112, v6
    v_add_u32 v17, v17, v5
    s_nop 0
    v_cndmask_b32 v17, v7, v17, vcc
    s_waitcnt vmcnt(10)
    s_barrier
    s_add_u32 m0, s54, 0
    s_add_u32 s42, s53, 3072
    buffer_load_dwordx4 v20, s[16:19], s53 offen lds
    s_add_u32 m0, m0, 1024
    s_add_u32 s53, s53, 129024
    buffer_load_dwordx4 v20, s[16:19], s42 offen lds
    s_add_u32 m0, m0, 1024
    s_add_u32 s42, s53, 3072
    buffer_load_dwordx4 v20, s[16:19], s53 offen lds
    s_add_u32 m0, m0, 1024
    s_add_u32 s53, s53, 129024
    buffer_load_dwordx4 v20, s[16:19], s42 offen lds
    s_add_u32 m0, m0, 1024
    s_add_u32 s42, s53, 3072
    buffer_load_dwordx4 v20, s[16:19], s53 offen lds
    s_add_u32 m0, m0, 1024
    s_add_u32 s53, s53, 129024
    buffer_load_dwordx4 v20, s[16:19], s42 offen lds
    s_waitcnt vmcnt(12)
    s_barrier
    s_add_u32 m0, s54, 6144
    s_add_u32 s42, s53, 3072
    buffer_load_dwordx4 v20, s[16:19], s53 offen lds
    s_add_u32 m0, m0, 1024
    s_add_u32 s53, s53, 129024
    buffer_load_dwordx4 v20, s[16:19], s42 offen lds
    s_add_u32 m0, m0, 1024
    s_add_u32 s42, s53, 3072
    buffer_load_dwordx4 v20, s[16:19], s53 offen lds
    s_add_u32 m0, m0, 1024
    s_add_u32 s53, s53, 129024
    buffer_load_dwordx4 v20, s[16:19], s42 offen lds
    s_add_u32 m0, m0, 1024
    s_add_u32 s42, s53, 3072
    buffer_load_dwordx4 v20, s[16:19], s53 offen lds
    s_add_u32 m0, m0, 1024
    s_add_u32 s53, s53, 129024
    buffer_load_dwordx4 v20, s[16:19], s42 offen lds
    s_add_u32 m0, m0, 1024
    s_add_u32 s42, s53, 3072
    buffer_load_dwordx4 v20, s[16:19], s53 offen lds
    s_add_u32 m0, m0, 1024
    s_add_u32 s53, s53, 129024
    buffer_load_dwordx4 v20, s[16:19], s42 offen lds
    s_waitcnt vmcnt(14)
    s_barrier
    s_mul_i32 s37, s55, 11
    v_add_u32 v4, s37, v1
    v_mul_u32_u24 v5, 1366, v4
    v_lshrrev_b32 v5, 16, v5
    v_mul_u32_u24 v6, 48, v5
    v_sub_u32 v6, v4, v6
    v_mul_u32_u24 v5, 129024, v5
    v_lshl_add_u32 v31, v6, 7, v5
    v_bfrev_b32 v7, 1
    v_cmp_gt_u32 vcc, 11, v1
    s_nop 1
    v_cndmask_b32 v31, v7, v31, vcc
    v_cmp_gt_u32 vcc, 336, v4
    s_nop 1
    v_cndmask_b32 v31, v7, v31, vcc
    s_mov_b32 s37, 36864
    buffer_load_dword v26, v31, s[16:19], s37 offen
    s_add_u32 s38, s49, 2
    s_cmp_ge_u32 s38, 7
    s_cselect_b32 s39, 7, 0
    s_sub_u32 s38, s38, s39
    s_cmp_eq_u32 s39, 7
    s_addc_u32 s40, s50, 0
    s_min_u32 s40, s40, 2
    s_mul_i32 s40, s40, 6144
    s_mul_i32 s38, s38, 18432
    s_add_u32 s37, s38, s40
    buffer_load_dword v26, v31, s[16:19], s37 offen
    v_lshrrev_b32 v4, 2, v1
    v_lshrrev_b32 v5, 1, v4
    v_and_b32 v5, 2, v5
    v_and_b32 v6, 3, v1
    v_xor_b32 v5, v5, v6
    v_lshlrev_b32 v5, 4, v5
    v_bfrev_b32 v7, 1
    s_lshl_b32 s37, s33, 4
    s_add_u32 s37, s37, 4093
    s_sub_u32 s37, s37, 4096
    v_add_u32 v6, s37, v4
    v_mul_u32_u24 v16, 384, v6
    v_cmp_gt_u32 vcc, 112, v6
    v_add_u32 v16, v16, v5
    s_nop 0
    v_cndmask_b32 v16, v7, v16, vcc
    s_add_u32 s49, s49, 1
    s_cmp_eq_u32 s49, 7
    s_cselect_b32 s49, 0, s49
    s_addc_u32 s50, s50, 0
    s_add_u32 s54, s54, s51
    s_sub_u32 s51, 0, s51
    s_waitcnt vmcnt(2) lgkmcnt(0)
    s_barrier
    s_mov_b32 s48, 1
    s_mul_i32 s53, s49, 18432
    s_mul_i32 s37, s50, 6144
    s_add_u32 s53, s53, s37
    s_add_u32 m0, s54, 0
    s_add_u32 s42, s53, 3072
    buffer_load_dwordx4 v20, s[16:19], s53 offen lds
    s_add_u32 m0, m0, 1024
    s_add_u32 s53, s53, 129024
    buffer_load_dwordx4 v20, s[16:19], s42 offen lds
    s_add_u32 m0, m0, 1024
    s_add_u32 s42, s53, 3072
    buffer_load_dwordx4 v20, s[16:19], s53 offen lds
    s_add_u32 m0, m0, 1024
    s_add_u32 s53, s53, 129024
    buffer_load_dwordx4 v20, s[16:19], s42 offen lds
    s_add_u32 m0, m0, 1024
    s_add_u32 s42, s53, 3072
    buffer_load_dwordx4 v20, s[16:19], s53 offen lds
    s_add_u32 m0, m0, 1024
    s_add_u32 s53, s53, 129024
    buffer_load_dwordx4 v20, s[16:19], s42 offen lds
    s_add_u32 m0, m0, 1024
    s_add_u32 s42, s53, 3072
    buffer_load_dwordx4 v20, s[16:19], s53 offen lds
    s_add_u32 m0, m0, 1024
    s_add_u32 s53, s53, 129024
    buffer_load_dwordx4 v20, s[16:19], s42 offen lds
    s_add_u32 m0, m0, 1024
    s_add_u32 s42, s53, 3072
    buffer_load_dwordx4 v20, s[16:19], s53 offen lds
    s_add_u32 m0, m0, 1024
    s_add_u32 s53, s53, 129024
    buffer_load_dwordx4 v20, s[16:19], s42 offen lds
    s_add_u32 m0, m0, 1024
    s_add_u32 s42, s53, 3072
    buffer_load_dwordx4 v20, s[16:19], s53 offen lds
    s_add_u32 m0, m0, 1024
    s_add_u32 s53, s53, 129024
    buffer_load_dwordx4 v20, s[16:19], s42 offen lds
    s_add_u32 m0, m0, 1024
    s_add_u32 s42, s53, 3072
    buffer_load_dwordx4 v20, s[16:19], s53 offen lds
    s_add_u32 m0, m0, 1024
    s_add_u32 s53, s53, 129024
    buffer_load_dwordx4 v20, s[16:19], s42 offen lds
    s_mov_b32 s59, s27
    s_mul_i32 s91, s59, 86016
    s_add_u32 s91, s91, s32
    s_mov_b64 exec, 0xffff00
    s_mov_b32 m0, 1024
    s_cmp_lt_u32 s59, 112
    s_cselect_b32 s62, s91, 0x40000000
    buffer_load_dwordx4 v17, s[12:15], s62 offen lds
    s_add_u32 m0, m0, 1408
    s_add_u32 s59, s59, 1
    s_add_u32 s91, s91, 86016
    s_cmp_lt_u32 s59, 112
    s_cselect_b32 s62, s91, 0x40000000
    buffer_load_dwordx4 v17, s[12:15], s62 offen lds
    s_add_u32 m0, m0, 1408
    s_add_u32 s59, s59, 1
    s_add_u32 s91, s91, 86016
    s_cmp_lt_u32 s59, 112
    s_cselect_b32 s62, s91, 0x40000000
    buffer_load_dwordx4 v17, s[12:15], s62 offen lds
    s_add_u32 m0, m0, 1408
    s_add_u32 s59, s59, 1
    s_add_u32 s91, s91, 86016
    s_cmp_lt_u32 s59, 112
    s_cselect_b32 s62, s91, 0x40000000
    buffer_load_dwordx4 v17, s[12:15], s62 offen lds
    s_add_u32 m0, m0, 1408
    s_add_u32 s59, s59, 1
    s_add_u32 s91, s91, 86016
    s_cmp_lt_u32 s59, 112
    s_cselect_b32 s62, s91, 0x40000000
    buffer_load_dwordx4 v17, s[12:15], s62 offen lds
    s_add_u32 m0, m0, 1408
    s_add_u32 s59, s59, 1
    s_add_u32 s91, s91, 86016
    s_cmp_lt_u32 s59, 112
    s_cselect_b32 s62, s91, 0x40000000
    buffer_load_dwordx4 v17, s[12:15], s62 offen lds
    s_add_u32 m0, m0, 1408
    s_add_u32 s59, s59, 1
    s_add_u32 s91, s91, 86016
    s_cmp_lt_u32 s59, 112
    s_cselect_b32 s62, s91, 0x40000000
    buffer_load_dwordx4 v17, s[12:15], s62 offen lds
    s_add_u32 m0, m0, 1408
    s_add_u32 s59, s59, 1
    s_add_u32 s91, s91, 86016
    s_cmp_lt_u32 s59, 112
    s_cselect_b32 s62, s91, 0x40000000
    buffer_load_dwordx4 v17, s[12:15], s62 offen lds
    s_add_u32 m0, m0, 1408
    s_add_u32 s59, s59, 1
    s_add_u32 s91, s91, 86016
    s_cmp_lt_u32 s59, 112
    s_cselect_b32 s62, s91, 0x40000000
    buffer_load_dwordx4 v17, s[12:15], s62 offen lds
    s_add_u32 m0, m0, 1408
    s_add_u32 s59, s59, 1
    s_add_u32 s91, s91, 86016
    s_cmp_lt_u32 s59, 112
    s_cselect_b32 s62, s91, 0x40000000
    buffer_load_dwordx4 v17, s[12:15], s62 offen lds
    s_add_u32 m0, m0, 1408
    s_add_u32 s59, s59, 1
    s_add_u32 s91, s91, 86016
    s_cmp_lt_u32 s59, 112
    s_cselect_b32 s62, s91, 0x40000000
    buffer_load_dwordx4 v17, s[12:15], s62 offen lds
    s_add_u32 m0, m0, 1408
    s_add_u32 s59, s59, 1
    s_add_u32 s91, s91, 86016
    s_cmp_lt_u32 s59, 112
    s_cselect_b32 s62, s91, 0x40000000
    buffer_load_dwordx4 v17, s[12:15], s62 offen lds
    s_add_u32 m0, m0, 1408
    s_add_u32 s59, s59, 1
    s_add_u32 s91, s91, 86016
    s_cmp_lt_u32 s59, 112
    s_cselect_b32 s62, s91, 0x40000000
    buffer_load_dwordx4 v17, s[12:15], s62 offen lds
    s_add_u32 m0, m0, 1408
    s_add_u32 s59, s59, 1
    s_add_u32 s91, s91, 86016
    s_cmp_lt_u32 s59, 112
    s_cselect_b32 s62, s91, 0x40000000
    buffer_load_dwordx4 v17, s[12:15], s62 offen lds
    s_add_u32 m0, m0, 1408
    s_add_u32 s59, s59, 1
    s_add_u32 s91, s91, 86016
    s_cmp_lt_u32 s59, 112
    s_cselect_b32 s62, s91, 0x40000000
    buffer_load_dwordx4 v17, s[12:15], s62 offen lds
    s_add_u32 m0, m0, 1408
    s_add_u32 s59, s59, 1
    s_add_u32 s91, s91, 86016
    s_cmp_lt_u32 s59, 112
    s_cselect_b32 s62, s91, 0x40000000
    buffer_load_dwordx4 v17, s[12:15], s62 offen lds
    s_add_u32 m0, m0, 1408
    s_add_u32 s59, s59, 1
    s_add_u32 s91, s91, 86016
    s_cmp_lt_u32 s59, 112
    s_cselect_b32 s62, s91, 0x40000000
    buffer_load_dwordx4 v17, s[12:15], s62 offen lds
    s_add_u32 m0, m0, 1408
    s_add_u32 s59, s59, 1
    s_add_u32 s91, s91, 86016
    s_cmp_lt_u32 s59, 112
    s_cselect_b32 s62, s91, 0x40000000
    buffer_load_dwordx4 v17, s[12:15], s62 offen lds
    s_add_u32 m0, m0, 1408
    s_add_u32 s59, s59, 1
    s_add_u32 s91, s91, 86016
    s_cmp_lt_u32 s59, 112
    s_cselect_b32 s62, s91, 0x40000000
    buffer_load_dwordx4 v17, s[12:15], s62 offen lds
    s_add_u32 m0, m0, 1408
    s_add_u32 s59, s59, 1
    s_add_u32 s91, s91, 86016
    s_cmp_lt_u32 s59, 112
    s_cselect_b32 s62, s91, 0x40000000
    buffer_load_dwordx4 v17, s[12:15], s62 offen lds
    s_add_u32 m0, m0, 1408
    s_add_u32 s59, s59, 1
    s_add_u32 s91, s91, 86016
    s_cmp_lt_u32 s59, 112
    s_cselect_b32 s62, s91, 0x40000000
    buffer_load_dwordx4 v17, s[12:15], s62 offen lds
    s_add_u32 m0, m0, 1408
    s_add_u32 s59, s59, 1
    s_add_u32 s91, s91, 86016
    s_cmp_lt_u32 s59, 112
    s_cselect_b32 s62, s91, 0x40000000
    buffer_load_dwordx4 v17, s[12:15], s62 offen lds
    s_add_u32 m0, m0, 1408
    s_add_u32 s59, s59, 1
    s_add_u32 s91, s91, 86016
    s_cmp_lt_u32 s59, 112
    s_cselect_b32 s62, s91, 0x40000000
    buffer_load_dwordx4 v17, s[12:15], s62 offen lds
    s_add_u32 m0, m0, 1408
    s_add_u32 s59, s59, 1
    s_add_u32 s91, s91, 86016
    s_cmp_lt_u32 s59, 112
    s_cselect_b32 s62, s91, 0x40000000
    buffer_load_dwordx4 v17, s[12:15], s62 offen lds
    s_add_u32 m0, m0, 1408
    s_add_u32 s59, s59, 1
    s_add_u32 s91, s91, 86016
    s_cmp_lt_u32 s59, 112
    s_cselect_b32 s62, s91, 0x40000000
    buffer_load_dwordx4 v17, s[12:15], s62 offen lds
    s_add_u32 m0, m0, 1408
    s_add_u32 s59, s59, 1
    s_add_u32 s91, s91, 86016
    s_cmp_lt_u32 s59, 112
    s_cselect_b32 s62, s91, 0x40000000
    buffer_load_dwordx4 v17, s[12:15], s62 offen lds
    s_add_u32 m0, m0, 1408
    s_add_u32 s59, s59, 1
    s_add_u32 s91, s91, 86016
    s_cmp_lt_u32 s59, 112
    s_cselect_b32 s62, s91, 0x40000000
    buffer_load_dwordx4 v17, s[12:15], s62 offen lds
    s_add_u32 m0, m0, 1408
    s_add_u32 s59, s59, 1
    s_add_u32 s91, s91, 86016
    s_cmp_lt_u32 s59, 112
    s_cselect_b32 s62, s91, 0x40000000
    buffer_load_dwordx4 v17, s[12:15], s62 offen lds
    s_add_u32 m0, m0, 1408
    s_add_u32 s59, s59, 1
    s_add_u32 s91, s91, 86016
    s_cmp_lt_u32 s59, 112
    s_cselect_b32 s62, s91, 0x40000000
    buffer_load_dwordx4 v17, s[12:15], s62 offen lds
    s_add_u32 m0, m0, 1408
    s_add_u32 s59, s59, 1
    s_add_u32 s91, s91, 86016
    s_cmp_lt_u32 s59, 112
    s_cselect_b32 s62, s91, 0x40000000
    buffer_load_dwordx4 v17, s[12:15], s62 offen lds
    s_add_u32 m0, m0, 1408
    s_add_u32 s59, s59, 1
    s_add_u32 s91, s91, 86016
    s_cmp_lt_u32 s59, 112
    s_cselect_b32 s62, s91, 0x40000000
    buffer_load_dwordx4 v17, s[12:15], s62 offen lds
    s_add_u32 m0, m0, 1408
    s_add_u32 s59, s59, 1
    s_add_u32 s91, s91, 86016
    s_cmp_lt_u32 s59, 112
    s_cselect_b32 s62, s91, 0x40000000
    buffer_load_dwordx4 v17, s[12:15], s62 offen lds
    s_add_u32 m0, m0, 1408
    s_add_u32 s59, s59, 1
    s_add_u32 s91, s91, 86016
    s_cmp_lt_u32 s59, 112
    s_cselect_b32 s62, s91, 0x40000000
    buffer_load_dwordx4 v17, s[12:15], s62 offen lds
    s_add_u32 m0, m0, 1408
    s_add_u32 s59, s59, 1
    s_add_u32 s91, s91, 86016
    s_cmp_lt_u32 s59, 112
    s_cselect_b32 s62, s91, 0x40000000
    buffer_load_dwordx4 v17, s[12:15], s62 offen lds
    s_add_u32 m0, m0, 1408
    s_add_u32 s59, s59, 1
    s_add_u32 s91, s91, 86016
    s_cmp_lt_u32 s59, 112
    s_cselect_b32 s62, s91, 0x40000000
    buffer_load_dwordx4 v17, s[12:15], s62 offen lds
    s_add_u32 m0, m0, 1408
    s_add_u32 s59, s59, 1
    s_add_u32 s91, s91, 86016
    s_cmp_lt_u32 s59, 112
    s_cselect_b32 s62, s91, 0x40000000
    buffer_load_dwordx4 v17, s[12:15], s62 offen lds
    s_add_u32 m0, m0, 1408
    s_add_u32 s59, s59, 1
    s_add_u32 s91, s91, 86016
    s_cmp_lt_u32 s59, 112
    s_cselect_b32 s62, s91, 0x40000000
    buffer_load_dwordx4 v17, s[12:15], s62 offen lds
    s_add_u32 m0, m0, 1408
    s_add_u32 s59, s59, 1
    s_add_u32 s91, s91, 86016
    s_cmp_lt_u32 s59, 112
    s_cselect_b32 s62, s91, 0x40000000
    buffer_load_dwordx4 v17, s[12:15], s62 offen lds
    s_add_u32 m0, m0, 1408
    s_add_u32 s59, s59, 1
    s_add_u32 s91, s91, 86016
    s_cmp_lt_u32 s59, 112
    s_cselect_b32 s62, s91, 0x40000000
    buffer_load_dwordx4 v17, s[12:15], s62 offen lds
    s_add_u32 m0, m0, 1408
    s_add_u32 s59, s59, 1
    s_add_u32 s91, s91, 86016
    s_cmp_lt_u32 s59, 112
    s_cselect_b32 s62, s91, 0x40000000
    buffer_load_dwordx4 v17, s[12:15], s62 offen lds
    s_add_u32 m0, m0, 1408
    s_add_u32 s59, s59, 1
    s_add_u32 s91, s91, 86016
    s_cmp_lt_u32 s59, 112
    s_cselect_b32 s62, s91, 0x40000000
    buffer_load_dwordx4 v17, s[12:15], s62 offen lds
    s_add_u32 m0, m0, 1408
    s_add_u32 s59, s59, 1
    s_add_u32 s91, s91, 86016
    s_cmp_lt_u32 s59, 112
    s_cselect_b32 s62, s91, 0x40000000
    buffer_load_dwordx4 v17, s[12:15], s62 offen lds
    s_add_u32 m0, m0, 1408
    s_add_u32 s59, s59, 1
    s_add_u32 s91, s91, 86016
    s_cmp_lt_u32 s59, 112
    s_cselect_b32 s62, s91, 0x40000000
    buffer_load_dwordx4 v17, s[12:15], s62 offen lds
    s_add_u32 m0, m0, 1408
    s_add_u32 s59, s59, 1
    s_add_u32 s91, s91, 86016
    s_cmp_lt_u32 s59, 112
    s_cselect_b32 s62, s91, 0x40000000
    buffer_load_dwordx4 v17, s[12:15], s62 offen lds
    s_mov_b64 exec, -1
    s_add_u32 s38, s49, 2
    s_cmp_ge_u32 s38, 7
    s_cselect_b32 s39, 7, 0
    s_sub_u32 s38, s38, s39
    s_cmp_eq_u32 s39, 7
    s_addc_u32 s40, s50, 0
    s_min_u32 s40, s40, 2
    s_mul_i32 s40, s40, 6144
    s_mul_i32 s38, s38, 18432
    s_add_u32 s37, s38, s40
    buffer_load_dword v26, v31, s[16:19], s37 offen
    s_waitcnt vmcnt(45)
    s_add_u32 s49, s49, 1
    s_cmp_eq_u32 s49, 7
    s_cselect_b32 s49, 0, s49
    s_addc_u32 s50, s50, 0
    s_add_u32 s54, s54, s51
    s_sub_u32 s51, 0, s51
    s_barrier
    s_mov_b32 s48, 2
L_lloop:
    s_mul_i32 s53, s49, 18432
    s_mul_i32 s37, s50, 6144
    s_add_u32 s53, s53, s37
    s_add_u32 m0, s54, 0
    s_add_u32 s42, s53, 3072
    buffer_load_dwordx4 v20, s[16:19], s53 offen lds
    s_add_u32 m0, m0, 1024
    s_add_u32 s53, s53, 129024
    buffer_load_dwordx4 v20, s[16:19], s42 offen lds
    s_add_u32 m0, m0, 1024
    s_add_u32 s42, s53, 3072
    buffer_load_dwordx4 v20, s[16:19], s53 offen lds
    s_add_u32 m0, m0, 1024
    s_add_u32 s53, s53, 129024
    buffer_load_dwordx4 v20, s[16:19], s42 offen lds
    s_add_u32 m0, m0, 1024
    s_add_u32 s42, s53, 3072
    buffer_load_dwordx4 v20, s[16:19], s53 offen lds
    s_add_u32 m0, m0, 1024
    s_add_u32 s53, s53, 129024
    buffer_load_dwordx4 v20, s[16:19], s42 offen lds
    s_add_u32 m0, m0, 1024
    s_add_u32 s42, s53, 3072
    buffer_load_dwordx4 v20, s[16:19], s53 offen lds
    s_add_u32 m0, m0, 1024
    s_add_u32 s53, s53, 129024
    buffer_load_dwordx4 v20, s[16:19], s42 offen lds
    s_add_u32 m0, m0, 1024
    s_add_u32 s42, s53, 3072
    buffer_load_dwordx4 v20, s[16:19], s53 offen lds
    s_add_u32 m0, m0, 1024
    s_add_u32 s53, s53, 129024
    buffer_load_dwordx4 v20, s[16:19], s42 offen lds
    s_add_u32 m0, m0, 1024
    s_add_u32 s42, s53, 3072
    buffer_load_dwordx4 v20, s[16:19], s53 offen lds
    s_add_u32 m0, m0, 1024
    s_add_u32 s53, s53, 129024
    buffer_load_dwordx4 v20, s[16:19], s42 offen lds
    s_add_u32 m0, m0, 1024
    s_add_u32 s42, s53, 3072
    buffer_load_dwordx4 v20, s[16:19], s53 offen lds
    s_add_u32 m0, m0, 1024
    s_add_u32 s53, s53, 129024
    buffer_load_dwordx4 v20, s[16:19], s42 offen lds
    s_mul_i32 s37, s48, 37
    s_lshr_b32 s37, s37, 8
    s_mul_i32 s38, s37, 7
    s_sub_u32 s38, s48, s38
    s_cmp_ge_u32 s37, 2
    s_cbranch_scc1 L_lnop
    s_sub_u32 s38, s38, 2
    s_cmp_ge_u32 s38, 4
    s_cbranch_scc1 L_lnop
    s_add_u32 s37, s37, 1
    s_lshl_b32 s64, s37, 6
    s_and_b32 s37, s37, 1
    s_mul_i32 s63, s37, 61952
    s_mul_i32 s58, s38, 11
    s_add_u32 s59, s27, s58
    s_mul_i32 s91, s59, 86016
    s_add_u32 s91, s91, s32
    s_add_u32 s91, s91, s64
    s_mul_i32 s61, s58, 1408
    s_add_u32 s61, s61, s63
    s_mov_b32 s38, s59
    s_mov_b32 s39, s91
    s_mov_b32 m0, s61
    s_waitcnt vmcnt(38)
    s_cmp_lt_u32 s38, 112
    s_cselect_b32 s62, s39, 0x40000000
    buffer_load_dwordx4 v16, s[12:15], s62 offen lds
    s_add_u32 m0, m0, 1408
    s_add_u32 s38, s38, 1
    s_add_u32 s39, s39, 86016
    s_cmp_lt_u32 s38, 112
    s_cselect_b32 s62, s39, 0x40000000
    buffer_load_dwordx4 v16, s[12:15], s62 offen lds
    s_add_u32 m0, m0, 1408
    s_add_u32 s38, s38, 1
    s_add_u32 s39, s39, 86016
    s_cmp_lt_u32 s38, 112
    s_cselect_b32 s62, s39, 0x40000000
    buffer_load_dwordx4 v16, s[12:15], s62 offen lds
    s_add_u32 m0, m0, 1408
    s_add_u32 s38, s38, 1
    s_add_u32 s39, s39, 86016
    s_cmp_lt_u32 s38, 112
    s_cselect_b32 s62, s39, 0x40000000
    buffer_load_dwordx4 v16, s[12:15], s62 offen lds
    s_add_u32 m0, m0, 1408
    s_add_u32 s38, s38, 1
    s_add_u32 s39, s39, 86016
    s_cmp_lt_u32 s38, 112
    s_cselect_b32 s62, s39, 0x40000000
    buffer_load_dwordx4 v16, s[12:15], s62 offen lds
    s_add_u32 m0, m0, 1408
    s_add_u32 s38, s38, 1
    s_add_u32 s39, s39, 86016
    s_cmp_lt_u32 s38, 112
    s_cselect_b32 s62, s39, 0x40000000
    buffer_load_dwordx4 v16, s[12:15], s62 offen lds
    s_add_u32 m0, m0, 1408
    s_add_u32 s38, s38, 1
    s_add_u32 s39, s39, 86016
    s_cmp_lt_u32 s38, 112
    s_cselect_b32 s62, s39, 0x40000000
    buffer_load_dwordx4 v16, s[12:15], s62 offen lds
    s_add_u32 m0, m0, 1408
    s_add_u32 s38, s38, 1
    s_add_u32 s39, s39, 86016
    s_cmp_lt_u32 s38, 112
    s_cselect_b32 s62, s39, 0x40000000
    buffer_load_dwordx4 v16, s[12:15], s62 offen lds
    s_add_u32 m0, m0, 1408
    s_add_u32 s38, s38, 1
    s_add_u32 s39, s39, 86016
    s_cmp_lt_u32 s38, 112
    s_cselect_b32 s62, s39, 0x40000000
    buffer_load_dwordx4 v16, s[12:15], s62 offen lds
    s_add_u32 m0, m0, 1408
    s_add_u32 s38, s38, 1
    s_add_u32 s39, s39, 86016
    s_cmp_lt_u32 s38, 112
    s_cselect_b32 s62, s39, 0x40000000
    buffer_load_dwordx4 v16, s[12:15], s62 offen lds
    s_add_u32 m0, m0, 1408
    s_add_u32 s38, s38, 1
    s_add_u32 s39, s39, 86016
    s_cmp_lt_u32 s38, 112
    s_cselect_b32 s62, s39, 0x40000000
    buffer_load_dwordx4 v16, s[12:15], s62 offen lds
    s_add_u32 m0, s61, 1024
    s_mov_b64 exec, s[56:57]
    s_cmp_lt_u32 s59, 112
    s_cselect_b32 s62, s91, 0x40000000
    buffer_load_dwordx4 v17, s[12:15], s62 offen lds
    s_add_u32 m0, m0, 1408
    s_add_u32 s59, s59, 1
    s_add_u32 s91, s91, 86016
    s_cmp_lt_u32 s59, 112
    s_cselect_b32 s62, s91, 0x40000000
    buffer_load_dwordx4 v17, s[12:15], s62 offen lds
    s_add_u32 m0, m0, 1408
    s_add_u32 s59, s59, 1
    s_add_u32 s91, s91, 86016
    s_cmp_lt_u32 s59, 112
    s_cselect_b32 s62, s91, 0x40000000
    buffer_load_dwordx4 v17, s[12:15], s62 offen lds
    s_add_u32 m0, m0, 1408
    s_add_u32 s59, s59, 1
    s_add_u32 s91, s91, 86016
    s_cmp_lt_u32 s59, 112
    s_cselect_b32 s62, s91, 0x40000000
    buffer_load_dwordx4 v17, s[12:15], s62 offen lds
    s_add_u32 m0, m0, 1408
    s_add_u32 s59, s59, 1
    s_add_u32 s91, s91, 86016
    s_cmp_lt_u32 s59, 112
    s_cselect_b32 s62, s91, 0x40000000
    buffer_load_dwordx4 v17, s[12:15], s62 offen lds
    s_add_u32 m0, m0, 1408
    s_add_u32 s59, s59, 1
    s_add_u32 s91, s91, 86016
    s_cmp_lt_u32 s59, 112
    s_cselect_b32 s62, s91, 0x40000000
    buffer_load_dwordx4 v17, s[12:15], s62 offen lds
    s_add_u32 m0, m0, 1408
    s_add_u32 s59, s59, 1
    s_add_u32 s91, s91, 86016
    s_cmp_lt_u32 s59, 112
    s_cselect_b32 s62, s91, 0x40000000
    buffer_load_dwordx4 v17, s[12:15], s62 offen lds
    s_add_u32 m0, m0, 1408
    s_add_u32 s59, s59, 1
    s_add_u32 s91, s91, 86016
    s_cmp_lt_u32 s59, 112
    s_cselect_b32 s62, s91, 0x40000000
    buffer_load_dwordx4 v17, s[12:15], s62 offen lds
    s_add_u32 m0, m0, 1408
    s_add_u32 s59, s59, 1
    s_add_u32 s91, s91, 86016
    s_cmp_lt_u32 s59, 112
    s_cselect_b32 s62, s91, 0x40000000
    buffer_load_dwordx4 v17, s[12:15], s62 offen lds
    s_add_u32 m0, m0, 1408
    s_add_u32 s59, s59, 1
    s_add_u32 s91, s91, 86016
    s_cmp_lt_u32 s59, 112
    s_cselect_b32 s62, s91, 0x40000000
    buffer_load_dwordx4 v17, s[12:15], s62 offen lds
    s_add_u32 m0, m0, 1408
    s_add_u32 s59, s59, 1
    s_add_u32 s91, s91, 86016
    s_cmp_lt_u32 s59, 112
    s_cselect_b32 s62, s91, 0x40000000
    buffer_load_dwordx4 v17, s[12:15], s62 offen lds
    s_mov_b64 exec, -1
    s_add_u32 s38, s49, 2
    s_cmp_ge_u32 s38, 7
    s_cselect_b32 s39, 7, 0
    s_sub_u32 s38, s38, s39
    s_cmp_eq_u32 s39, 7
    s_addc_u32 s40, s50, 0
    s_min_u32 s40, s40, 2
    s_mul_i32 s40, s40, 6144
    s_mul_i32 s38, s38, 18432
    s_add_u32 s37, s38, s40
    buffer_load_dword v26, v31, s[16:19], s37 offen
    s_waitcnt vmcnt(23)
    s_branch L_lbar
L_lnop:
    s_add_u32 s38, s49, 2
    s_cmp_ge_u32 s38, 7
    s_cselect_b32 s39, 7, 0
    s_sub_u32 s38, s38, s39
    s_cmp_eq_u32 s39, 7
    s_addc_u32 s40, s50, 0
    s_min_u32 s40, s40, 2
    s_mul_i32 s40, s40, 6144
    s_mul_i32 s38, s38, 18432
    s_add_u32 s37, s38, s40
    buffer_load_dword v26, v31, s[16:19], s37 offen
    s_waitcnt vmcnt(1)
L_lbar:
    s_add_u32 s49, s49, 1
    s_cmp_eq_u32 s49, 7
    s_cselect_b32 s49, 0, s49
    s_addc_u32 s50, s50, 0
    s_add_u32 s54, s54, s51
    s_sub_u32 s51, 0, s51
    s_barrier
    s_add_u32 s48, s48, 1
    s_cmp_lt_u32 s48, 20
    s_cbranch_scc1 L_lloop
L_end:
    s_endpgm
.section .rodata,"a"
.p2align 6
.amdhsa_kernel standalone__dilated_atrous__vision_kernel
  .amdhsa_next_free_vgpr 236
  .amdhsa_next_free_sgpr 96
  .amdhsa_accum_offset 92
  .amdhsa_group_segment_fixed_size 0
  .amdhsa_kernarg_size 40
  .amdhsa_user_sgpr_count 2
  .amdhsa_user_sgpr_kernarg_segment_ptr 1
  .amdhsa_system_sgpr_workgroup_id_x 1
.end_amdhsa_kernel
```
